```python
import torch

def _softmax(x, axis=-1):
    return torch.softmax(x, dim=axis)

def _gelu(x):
    return torch.nn.functional.gelu(x, approximate='tanh')

def _silu(x):
    return torch.nn.functional.silu(x)

def _sigmoid(x):
    return torch.sigmoid(x)

def _layernorm(x, axis=-1, eps=1e-05):
    m = x.mean(dim=axis, keepdim=True)
    v = x.var(dim=axis, keepdim=True, unbiased=False)
    return (x - m) / torch.sqrt(v + eps)

def _scatter_add(tgt, idx, src, axis=0):
    return tgt.clone().index_add_(axis, idx, src)

def _segment_sum(src, seg, n):
    out = torch.zeros((n,) + src.shape[1:], dtype=src.dtype)
    return out.index_add_(0, seg, src)

def _pad(x, pw):
    flat = tuple((v for pair in reversed(pw) for v in pair))
    return torch.nn.functional.pad(x, flat)
kernel_name = 'standalone__kv_cache_quant_pre_rope_vs_post_rope__prompt'

def setup_inputs():

    _w = lambda a: (lambda t: t.to(torch.bfloat16) if t.is_floating_point() else t)(torch.as_tensor(a))
    B, Sq, Skv = (1, 2048, 2048)
    H, Dh0 = (8, 128)
    G = -1 if -1 > 0 else Dh0
    G = max(2, G // 2 * 2)
    Dh = max(G, Dh0 // G * G)
    Skv = max(Skv, Sq)
    ng = Dh // G
    bits = 2 if 2 > 1 else 4
    bits = max(2, min(8, bits))
    qmax = (1 << bits) - 1
    half = Dh // 2
    inv = 1.0 / 10000.0 ** (torch.arange(half) / max(1, half))
    ang_k = torch.arange(Skv)[:, None] * inv[None, :]
    ang_q = torch.arange(Skv - Sq, Skv)[:, None] * inv[None, :]
    kc = torch.cat([torch.cos(ang_k), torch.cos(ang_k)], dim=-1)
    ks = torch.cat([torch.sin(ang_k), torch.sin(ang_k)], dim=-1)
    qc = torch.cat([torch.cos(ang_q), torch.cos(ang_q)], dim=-1)
    qs = torch.cat([torch.sin(ang_q), torch.sin(ang_q)], dim=-1)
    qk_i = torch.randint(0, qmax + 1, (B, H, Skv, Dh)).to(torch.int32)
    qv_i = torch.randint(0, qmax + 1, (B, H, Skv, Dh)).to(torch.int32)
    ksc = torch.abs((lambda *s: torch.randn(*s, dtype=torch.bfloat16) * 0.4)(B, H, Skv, ng)) * 0.1 + 0.01
    kzp = torch.full((B, H, Skv, ng), qmax / 2.0)
    vsc = torch.abs((lambda *s: torch.randn(*s, dtype=torch.bfloat16) * 0.4)(B, H, Skv, ng)) * 0.1 + 0.01
    vzp = torch.full((B, H, Skv, ng), qmax / 2.0)
    return {'q': _w((lambda *s: torch.randn(*s, dtype=torch.bfloat16) * 6.4)(B, H, Sq, Dh) * 0.5), 'qk': _w(qk_i), 'k_scales': _w(ksc), 'k_zeros': _w(kzp), 'qv': _w(qv_i), 'v_scales': _w(vsc), 'v_zeros': _w(vzp), 'q_cos': _w(qc), 'q_sin': _w(qs), 'k_cos': _w(kc), 'k_sin': _w(ks)}

def reference(q, qk, k_scales, k_zeros, qv, v_scales, v_zeros, q_cos, q_sin, k_cos, k_sin):
    B, H, Sq, Dh = q.shape
    ng = k_scales.shape[-1]
    G = Dh // ng
    half = Dh // 2
    ks = (lambda x, n, axis: torch.repeat_interleave(x, n, dim=axis))(k_scales, G, axis=-1)
    kz = (lambda x, n, axis: torch.repeat_interleave(x, n, dim=axis))(k_zeros, G, axis=-1)
    k = ((lambda x, dt: x.to(dt))(qk, q.dtype) - kz) * ks
    vs = (lambda x, n, axis: torch.repeat_interleave(x, n, dim=axis))(v_scales, G, axis=-1)
    vz = (lambda x, n, axis: torch.repeat_interleave(x, n, dim=axis))(v_zeros, G, axis=-1)
    v = ((lambda x, dt: x.to(dt))(qv, q.dtype) - vz) * vs
    k1 = k[..., :half].clone()
    k2 = k[..., half:].clone()
    krh = torch.concatenate([-k2, k1], axis=-1)
    kr = k * k_cos[None, None, :, :] + krh * k_sin[None, None, :, :]
    q1 = q[..., :half].clone()
    q2 = q[..., half:].clone()
    qrh = torch.concatenate([-q2, q1], axis=-1)
    qr = q * q_cos[None, None, :, :] + qrh * q_sin[None, None, :, :]
    logits = torch.einsum('bhqd,bhkd->bhqk', qr, kr) * float(Dh) ** (-0.5)
    attn = _softmax(logits, axis=-1)
    out = torch.einsum('bhqk,bhkd->bhqd', attn, v)
    return out
```

```asm
; @launch grid=(256,1,1) block=(256,1,1) lds=122880
.amdgcn_target "amdgcn-amd-amdhsa--gfx950"
.text
.globl standalone__kv_cache_quant_pre_rope_vs_post_rope__prompt_kernel
.p2align 8
.type standalone__kv_cache_quant_pre_rope_vs_post_rope__prompt_kernel,@function
standalone__kv_cache_quant_pre_rope_vs_post_rope__prompt_kernel:
    s_cmp_ge_u32 s2, 256
    s_cbranch_scc1 L_end
    s_load_dwordx16 s[16:31], s[0:1], 0
    s_load_dwordx8 s[32:39], s[0:1], 64
    s_load_dwordx4 s[40:43], s[0:1], 96
    s_and_b32 s7, s2, 7
    s_lshr_b32 s8, s2, 3
    s_and_b32 s4, s7, 3
    s_lshl_b32 s4, s4, 1
    s_and_b32 s101, s8, 1
    s_add_u32 s4, s4, s101
    s_lshr_b32 s5, s7, 2
    s_lshl_b32 s5, s5, 4
    s_lshr_b32 s101, s8, 1
    s_add_u32 s5, s5, s101
    v_lshrrev_b32 v1, 6, v0
    v_and_b32 v2, 63, v0
    v_readfirstlane_b32 s3, v1
    v_lshlrev_b32 v4, 4, v2
    s_getpc_b64 s[44:45]
L_pc:
    v_lshlrev_b32 v5, 6, v0
    v_add_u32 v6, 0x0, v5
    v_min_u32 v6, (L_code_end - L_pc - 4), v6
    global_load_dword a250, v6, s[44:45]
    v_add_u32 v6, 0x4000, v5
    v_min_u32 v6, (L_code_end - L_pc - 4), v6
    global_load_dword a251, v6, s[44:45]
    v_add_u32 v5, 0x1000, v4
    v_add_u32 v6, 0x2000, v4
    v_add_u32 v7, 0x3000, v4
    s_lshl_b32 s101, s7, 4
    s_and_b32 s7, s8, 1
    s_lshr_b32 s8, s8, 1
    s_add_u32 s8, s8, s101
    v_lshrrev_b32 v56, 7, v0
    v_lshlrev_b32 v56, 3, v56
    v_bfe_u32 v57, v0, 3, 3
    v_add_u32 v56, v56, v57
    v_bfe_u32 v57, v0, 6, 1
    v_lshlrev_b32 v57, 3, v57
    v_and_b32 v58, 7, v0
    v_add_u32 v57, v57, v58
    s_lshl_b32 s101, s8, 4
    v_mul_u32_u24 v208, 25600, v1
    v_lshl_add_u32 v209, v56, 1, v208
    v_add_u32 v58, s101, v56
    v_lshlrev_b32 v42, 9, v58
    v_lshl_add_u32 v42, v57, 4, v42
    s_lshr_b32 s15, s8, 3
    s_lshl_b32 s15, s15, 14
    s_bfe_u32 s14, s8, 0x10002
    s_lshl_b32 s13, s14, 8
    s_add_u32 s13, s13, s15
    v_lshrrev_b32 v45, 1, v57
    v_lshlrev_b32 v45, 10, v45
    v_and_b32 v57, 1, v57
    v_lshl_add_u32 v45, v57, 9, v45
    v_lshl_add_u32 v45, v56, 4, v45
    v_add_u32 v45, s13, v45
    v_lshrrev_b32 v56, 7, v0
    v_lshlrev_b32 v56, 3, v56
    v_bfe_u32 v57, v0, 2, 3
    v_add3_u32 v56, v56, v57, s101
    v_lshlrev_b32 v43, 8, v56
    v_bfe_u32 v57, v0, 5, 1
    v_lshl_add_u32 v43, v57, 7, v43
    v_lshl_add_u32 v48, v57, 9, v208
    v_lshl_add_u32 v210, v57, 3, v208
    v_bfe_u32 v57, v0, 6, 1
    v_lshl_add_u32 v43, v57, 6, v43
    v_and_b32 v57, 3, v0
    v_lshl_add_u32 v43, v57, 4, v43
    v_lshrrev_b32 v56, 3, v2
    v_add_u32 v56, s101, v56
    v_lshlrev_b32 v46, 9, v56
    v_lshl_add_u32 v46, v1, 7, v46
    v_and_b32 v57, 7, v0
    v_lshl_add_u32 v46, v57, 4, v46
    v_lshrrev_b32 v56, 3, v0
    v_add_u32 v56, s8, v56
    v_and_b32 v56, 3, v56
    v_lshlrev_b32 v44, 12, v56
    v_lshl_add_u32 v44, v57, 2, v44
    s_lshl_b32 s97, s7, 14
    s_lshl_b32 s13, s8, 5
    s_add_u32 s97, s97, s13
    v_add_u32 v44, s97, v44
    v_and_b32 v57, 31, v2
    v_lshl_add_u32 v48, v57, 2, v48
    v_lshl_add_u32 v47, v2, 3, v208
    v_add_u32 v208, v208, v4
    s_lshl_b32 s97, s14, 12
    s_add_u32 s97, s97, s15
    s_add_u32 s97, s97, 0x2000
    v_lshlrev_b32 v49, 4, v0
    v_add_u32 v49, s97, v49
    s_lshr_b32 s97, s8, 2
    s_lshl_b32 s97, s97, 5
    s_add_u32 s97, s97, 0x100000
    v_lshlrev_b32 v50, 3, v1
    v_add_u32 v50, s97, v50
    s_lshl_b32 s14, s4, 21
    s_add_u32 s97, s14, 0x100000
    v_and_b32 v51, 31, v2
    v_lshlrev_b32 v51, 3, v51
    v_lshl_add_u32 v51, v1, 8, v51
    v_add_u32 v51, s97, v51
    v_lshrrev_b32 v56, 3, v2
    v_lshl_add_u32 v56, v1, 4, v56
    s_lshl_b32 s97, s5, 6
    v_add_u32 v57, s97, v56
    v_lshlrev_b32 v241, 8, v57
    v_and_b32 v58, 7, v2
    v_lshl_add_u32 v241, v58, 4, v241
    s_lshl_b32 s97, s4, 19
    v_add_u32 v240, s97, v241
    v_lshrrev_b32 v57, 1, v1
    v_lshl_add_u32 v57, v57, 3, v58
    v_mul_u32_u24 v244, 1040, v57
    v_and_b32 v56, 31, v56
    v_lshl_add_u32 v244, v56, 4, v244
    v_add_u32 v244, 0x19000, v244
    v_add_u32 v245, 0x19000, v4
    s_lshl_b32 s97, s3, 16
    s_add_u32 s97, s97, s14
    s_add_u32 s9, s5, 0
    s_and_b32 s9, s9, 3
    s_lshl_b32 s9, s9, 14
    s_add_u32 s9, s9, s97
    s_add_u32 s10, s5, 1
    s_and_b32 s10, s10, 3
    s_lshl_b32 s10, s10, 14
    s_add_u32 s10, s10, s97
    s_add_u32 s11, s5, 2
    s_and_b32 s11, s11, 3
    s_lshl_b32 s11, s11, 14
    s_add_u32 s11, s11, s97
    s_add_u32 s12, s5, 3
    s_and_b32 s12, s12, 3
    s_lshl_b32 s12, s12, 14
    s_add_u32 s12, s12, s97
    s_mov_b32 s6, 0x45800000
    s_mov_b32 s98, 0x05040100
    s_mov_b32 s99, 0x07060302
    s_mov_b32 s100, 0x3e0293ee
    s_mov_b32 s101, 0x1000000
    s_waitcnt lgkmcnt(0)
    s_load_dwordx2 s[96:97], s[42:43], s101
    s_mov_b32 s44, s16
    s_and_b32 s45, s17, 0xffff
    s_mov_b32 s46, 0x400000
    s_mov_b32 s47, 0x20000
    s_mul_i32 s16, s3, 25600
    s_mov_b32 s48, s18
    s_and_b32 s49, s19, 0xffff
    s_mov_b32 s50, 0x800000
    s_mov_b32 s51, 0x20000
    s_mov_b32 s80, s34
    s_and_b32 s81, s35, 0xffff
    s_mov_b32 s82, 0x80000
    s_mov_b32 s83, 0x20000
    s_mov_b32 s84, s36
    s_and_b32 s85, s37, 0xffff
    s_mov_b32 s86, 0x80000
    s_mov_b32 s87, 0x20000
    s_mov_b32 s60, s24
    s_and_b32 s61, s25, 0xffff
    s_mov_b32 s62, 0x800000
    s_mov_b32 s63, 0x20000
    s_mov_b32 s52, s20
    s_and_b32 s53, s21, 0xffff
    s_mov_b32 s54, 0x8000
    s_mov_b32 s55, 0x20000
    s_mov_b32 s56, s22
    s_and_b32 s57, s23, 0xffff
    s_mov_b32 s58, 0x8000
    s_mov_b32 s59, 0x20000
    s_mov_b32 s64, s26
    s_and_b32 s65, s27, 0xffff
    s_mov_b32 s66, 0x8000
    s_mov_b32 s67, 0x20000
    s_mov_b32 s68, s28
    s_and_b32 s69, s29, 0xffff
    s_mov_b32 s70, 0x8000
    s_mov_b32 s71, 0x20000
    s_lshl_b32 s13, s7, 2
    s_add_u32 s18, s8, 0
    s_and_b32 s18, s18, 3
    s_add_u32 s18, s18, s13
    s_lshl_b32 s18, s18, 20
    s_add_u32 s19, s8, 1
    s_and_b32 s19, s19, 3
    s_add_u32 s19, s19, s13
    s_lshl_b32 s19, s19, 20
    s_add_u32 s20, s8, 2
    s_and_b32 s20, s20, 3
    s_add_u32 s20, s20, s13
    s_lshl_b32 s20, s20, 20
    s_add_u32 s21, s8, 3
    s_and_b32 s21, s21, 3
    s_add_u32 s21, s21, s13
    s_lshl_b32 s21, s21, 20
    s_add_u32 m0, s16, 0x0
    s_add_u32 s13, s18, 0x0
    buffer_load_dwordx4 v42, s[48:51], s13 offen lds
    s_add_u32 m0, s16, 0x400
    s_add_u32 s13, s18, 0x100
    buffer_load_dwordx4 v42, s[48:51], s13 offen lds
    s_add_u32 m0, s16, 0x800
    s_mov_b32 s13, 0x0
    buffer_load_dwordx4 v43, s[80:83], s13 offen lds
    s_add_u32 m0, s16, 0xc00
    s_mov_b32 s13, 0x0
    buffer_load_dwordx4 v43, s[84:87], s13 offen lds
    s_add_u32 m0, s16, 0x6000
    s_mov_b32 s13, 0x0
    buffer_load_dword v44, s[52:55], s13 offen lds
    s_add_u32 m0, s16, 0x6100
    s_mov_b32 s13, 0x0
    buffer_load_dword v44, s[56:59], s13 offen lds
    s_add_u32 m0, s16, 0x6200
    s_mov_b32 s13, 0x0
    buffer_load_dword v44, s[64:67], s13 offen lds
    s_add_u32 m0, s16, 0x6300
    s_mov_b32 s13, 0x0
    buffer_load_dword v44, s[68:71], s13 offen lds
    s_add_u32 m0, s16, 0x1000
    s_add_u32 s13, s18, 0x0
    buffer_load_dwordx4 v46, s[60:63], s13 offen lds
    s_add_u32 m0, s16, 0x1400
    s_add_u32 s13, s18, 0x1000
    buffer_load_dwordx4 v46, s[60:63], s13 offen lds
    s_mov_b32 s22, 0x3f803f80
    s_mov_b32 s72, s30
    s_and_b32 s73, s31, 0xffff
    s_mov_b32 s74, 0x80000
    s_mov_b32 s75, 0x20000
    s_mov_b32 s76, s32
    s_and_b32 s77, s33, 0xffff
    s_mov_b32 s78, 0x80000
    s_mov_b32 s79, 0x20000
    s_mov_b32 s88, s38
    s_and_b32 s89, s39, 0xffff
    s_mov_b32 s90, 0x400000
    s_mov_b32 s91, 0x20000
    s_mov_b32 s92, s42
    s_and_b32 s93, s43, 0xffff
    s_mov_b32 s94, 0x1001000
    s_mov_b32 s95, 0x20000
    buffer_load_dwordx4 v[64:67], v240, s[44:47], 0 offen offset:0
    buffer_load_dwordx4 v[68:71], v240, s[44:47], 0 offen offset:128
    buffer_load_dwordx4 v[72:75], v241, s[72:75], 0 offen offset:0
    buffer_load_dwordx4 v[76:79], v241, s[72:75], 0 offen offset:128
    buffer_load_dwordx4 v[80:83], v241, s[76:79], 0 offen offset:0
    buffer_load_dwordx4 v[84:87], v241, s[76:79], 0 offen offset:128
    buffer_load_dwordx4 v[88:91], v240, s[44:47], 0 offen offset:2048
    buffer_load_dwordx4 v[92:95], v240, s[44:47], 0 offen offset:2176
    buffer_load_dwordx4 v[96:99], v241, s[72:75], 0 offen offset:2048
    buffer_load_dwordx4 v[100:103], v241, s[72:75], 0 offen offset:2176
    buffer_load_dwordx4 v[104:107], v241, s[76:79], 0 offen offset:2048
    buffer_load_dwordx4 v[108:111], v241, s[76:79], 0 offen offset:2176
    v_accvgpr_write_b32 a0, 0
    v_accvgpr_write_b32 a1, 0
    v_accvgpr_write_b32 a2, 0
    v_accvgpr_write_b32 a3, 0
    v_accvgpr_write_b32 a4, 0
    v_accvgpr_write_b32 a5, 0
    v_accvgpr_write_b32 a6, 0
    v_accvgpr_write_b32 a7, 0
    v_accvgpr_write_b32 a8, 0
    v_accvgpr_write_b32 a9, 0
    v_accvgpr_write_b32 a10, 0
    v_accvgpr_write_b32 a11, 0
    v_accvgpr_write_b32 a12, 0
    v_accvgpr_write_b32 a13, 0
    v_accvgpr_write_b32 a14, 0
    v_accvgpr_write_b32 a15, 0
    v_accvgpr_write_b32 a16, 0
    v_accvgpr_write_b32 a17, 0
    v_accvgpr_write_b32 a18, 0
    v_accvgpr_write_b32 a19, 0
    v_accvgpr_write_b32 a20, 0
    v_accvgpr_write_b32 a21, 0
    v_accvgpr_write_b32 a22, 0
    v_accvgpr_write_b32 a23, 0
    v_accvgpr_write_b32 a24, 0
    v_accvgpr_write_b32 a25, 0
    v_accvgpr_write_b32 a26, 0
    v_accvgpr_write_b32 a27, 0
    v_accvgpr_write_b32 a28, 0
    v_accvgpr_write_b32 a29, 0
    v_accvgpr_write_b32 a30, 0
    v_accvgpr_write_b32 a31, 0
    v_accvgpr_write_b32 a32, 0
    v_accvgpr_write_b32 a33, 0
    v_accvgpr_write_b32 a34, 0
    v_accvgpr_write_b32 a35, 0
    v_accvgpr_write_b32 a36, 0
    v_accvgpr_write_b32 a37, 0
    v_accvgpr_write_b32 a38, 0
    v_accvgpr_write_b32 a39, 0
    v_accvgpr_write_b32 a40, 0
    v_accvgpr_write_b32 a41, 0
    v_accvgpr_write_b32 a42, 0
    v_accvgpr_write_b32 a43, 0
    v_accvgpr_write_b32 a44, 0
    v_accvgpr_write_b32 a45, 0
    v_accvgpr_write_b32 a46, 0
    v_accvgpr_write_b32 a47, 0
    v_accvgpr_write_b32 a48, 0
    v_accvgpr_write_b32 a49, 0
    v_accvgpr_write_b32 a50, 0
    v_accvgpr_write_b32 a51, 0
    v_accvgpr_write_b32 a52, 0
    v_accvgpr_write_b32 a53, 0
    v_accvgpr_write_b32 a54, 0
    v_accvgpr_write_b32 a55, 0
    v_accvgpr_write_b32 a56, 0
    v_accvgpr_write_b32 a57, 0
    v_accvgpr_write_b32 a58, 0
    v_accvgpr_write_b32 a59, 0
    v_accvgpr_write_b32 a60, 0
    v_accvgpr_write_b32 a61, 0
    v_accvgpr_write_b32 a62, 0
    v_accvgpr_write_b32 a63, 0
    v_accvgpr_write_b32 a64, 0
    v_accvgpr_write_b32 a65, 0
    v_accvgpr_write_b32 a66, 0
    v_accvgpr_write_b32 a67, 0
    v_accvgpr_write_b32 a68, 0
    v_accvgpr_write_b32 a69, 0
    v_accvgpr_write_b32 a70, 0
    v_accvgpr_write_b32 a71, 0
    v_accvgpr_write_b32 a72, 0
    v_accvgpr_write_b32 a73, 0
    v_accvgpr_write_b32 a74, 0
    v_accvgpr_write_b32 a75, 0
    v_accvgpr_write_b32 a76, 0
    v_accvgpr_write_b32 a77, 0
    v_accvgpr_write_b32 a78, 0
    v_accvgpr_write_b32 a79, 0
    v_accvgpr_write_b32 a80, 0
    v_accvgpr_write_b32 a81, 0
    v_accvgpr_write_b32 a82, 0
    v_accvgpr_write_b32 a83, 0
    v_accvgpr_write_b32 a84, 0
    v_accvgpr_write_b32 a85, 0
    v_accvgpr_write_b32 a86, 0
    v_accvgpr_write_b32 a87, 0
    v_accvgpr_write_b32 a88, 0
    v_accvgpr_write_b32 a89, 0
    v_accvgpr_write_b32 a90, 0
    v_accvgpr_write_b32 a91, 0
    v_accvgpr_write_b32 a92, 0
    v_accvgpr_write_b32 a93, 0
    v_accvgpr_write_b32 a94, 0
    v_accvgpr_write_b32 a95, 0
    v_accvgpr_write_b32 a96, 0
    v_accvgpr_write_b32 a97, 0
    v_accvgpr_write_b32 a98, 0
    v_accvgpr_write_b32 a99, 0
    v_accvgpr_write_b32 a100, 0
    v_accvgpr_write_b32 a101, 0
    v_accvgpr_write_b32 a102, 0
    v_accvgpr_write_b32 a103, 0
    v_accvgpr_write_b32 a104, 0
    v_accvgpr_write_b32 a105, 0
    v_accvgpr_write_b32 a106, 0
    v_accvgpr_write_b32 a107, 0
    v_accvgpr_write_b32 a108, 0
    v_accvgpr_write_b32 a109, 0
    v_accvgpr_write_b32 a110, 0
    v_accvgpr_write_b32 a111, 0
    v_accvgpr_write_b32 a112, 0
    v_accvgpr_write_b32 a113, 0
    v_accvgpr_write_b32 a114, 0
    v_accvgpr_write_b32 a115, 0
    v_accvgpr_write_b32 a116, 0
    v_accvgpr_write_b32 a117, 0
    v_accvgpr_write_b32 a118, 0
    v_accvgpr_write_b32 a119, 0
    v_accvgpr_write_b32 a120, 0
    v_accvgpr_write_b32 a121, 0
    v_accvgpr_write_b32 a122, 0
    v_accvgpr_write_b32 a123, 0
    v_accvgpr_write_b32 a124, 0
    v_accvgpr_write_b32 a125, 0
    v_accvgpr_write_b32 a126, 0
    v_accvgpr_write_b32 a127, 0
    s_waitcnt lgkmcnt(0)
    s_add_u32 s96, s96, 1
    s_add_u32 s97, s97, 0x9e3779b9
    v_mov_b32 v52, s96
    v_mov_b32 v53, s97
    s_waitcnt vmcnt(14)
    ds_read_u16 v160, v209 offset:24576
    ds_read_u16 v161, v209 offset:24832
    ds_read_b128 v[128:131], v208 offset:0
    ds_read_b128 v[132:135], v208 offset:1024
    ds_read_b64 v[136:137], v47 offset:2048
    ds_read_b64 v[138:139], v47 offset:2560
    ds_read_b64 v[140:141], v47 offset:3072
    ds_read_b64 v[142:143], v47 offset:3584
    ds_read_b64 v[152:153], v210 offset:25088
    ds_read_b64 v[154:155], v210 offset:25104
    ds_read_b64 v[156:157], v210 offset:25344
    ds_read_b64 v[158:159], v210 offset:25360
    s_lshl_b32 s14, s18, 1
    s_add_u32 s14, s14, 0x0
    s_waitcnt lgkmcnt(8)
    v_lshlrev_b32 v160, 16, v160
    v_lshlrev_b32 v161, 16, v161
    v_cvt_f32_i32 v128, v128
    v_cvt_f32_i32 v129, v129
    v_cvt_f32_i32 v130, v130
    v_cvt_f32_i32 v131, v131
    v_cvt_f32_i32 v132, v132
    v_cvt_f32_i32 v133, v133
    v_cvt_f32_i32 v134, v134
    v_cvt_f32_i32 v135, v135
    v_cvt_pk_bf16_f32 v128, 0, v128
    v_cvt_pk_bf16_f32 v129, 0, v129
    v_cvt_pk_bf16_f32 v130, 0, v130
    v_cvt_pk_bf16_f32 v131, 0, v131
    v_cvt_pk_bf16_f32 v132, 0, v132
    v_cvt_pk_bf16_f32 v133, 0, v133
    v_cvt_pk_bf16_f32 v134, 0, v134
    v_cvt_pk_bf16_f32 v135, 0, v135
    v_sub_f32 v128, v128, v161
    v_sub_f32 v129, v129, v161
    v_sub_f32 v130, v130, v161
    v_sub_f32 v131, v131, v161
    v_sub_f32 v132, v132, v161
    v_sub_f32 v133, v133, v161
    v_sub_f32 v134, v134, v161
    v_sub_f32 v135, v135, v161
    v_cvt_pk_bf16_f32 v128, 0, v128
    v_cvt_pk_bf16_f32 v129, 0, v129
    v_cvt_pk_bf16_f32 v130, 0, v130
    v_cvt_pk_bf16_f32 v131, 0, v131
    v_cvt_pk_bf16_f32 v132, 0, v132
    v_cvt_pk_bf16_f32 v133, 0, v133
    v_cvt_pk_bf16_f32 v134, 0, v134
    v_cvt_pk_bf16_f32 v135, 0, v135
    v_mul_f32 v128, v128, v160
    v_mul_f32 v129, v129, v160
    v_mul_f32 v130, v130, v160
    v_mul_f32 v131, v131, v160
    v_mul_f32 v132, v132, v160
    v_mul_f32 v133, v133, v160
    v_mul_f32 v134, v134, v160
    v_mul_f32 v135, v135, v160
    v_cvt_pk_bf16_f32 v246, v128, v132
    v_cvt_pk_bf16_f32 v247, v129, v133
    v_cvt_pk_bf16_f32 v248, v130, v134
    v_cvt_pk_bf16_f32 v249, v131, v135
    s_waitcnt vmcnt(12)
    ds_read_b32 v144, v48 offset:4096
    ds_read_b32 v145, v48 offset:4224
    ds_read_b32 v146, v48 offset:4352
    ds_read_b32 v147, v48 offset:4480
    ds_read_b32 v148, v48 offset:5120
    ds_read_b32 v149, v48 offset:5248
    ds_read_b32 v150, v48 offset:5376
    ds_read_b32 v151, v48 offset:5504
    s_waitcnt lgkmcnt(12)
    v_perm_b32 v56, v140, v136, s98
    v_perm_b32 v60, v138, v142, s98
    v_perm_b32 v57, v140, v136, s99
    v_perm_b32 v61, v138, v142, s99
    v_perm_b32 v58, v141, v137, s98
    v_perm_b32 v62, v139, v143, s98
    v_perm_b32 v59, v141, v137, s99
    v_perm_b32 v63, v139, v143, s99
    v_dot2_f32_bf16 v128, v246, v56, 0 neg_hi:[0,1,0]
    v_dot2_f32_bf16 v129, v247, v57, 0 neg_hi:[0,1,0]
    v_dot2_f32_bf16 v130, v248, v58, 0 neg_hi:[0,1,0]
    v_dot2_f32_bf16 v131, v249, v59, 0 neg_hi:[0,1,0]
    v_dot2_f32_bf16 v132, v246, v60, 0
    v_dot2_f32_bf16 v133, v247, v61, 0
    v_dot2_f32_bf16 v134, v248, v62, 0
    v_dot2_f32_bf16 v135, v249, v63, 0
    s_waitcnt lgkmcnt(0)
    v_cvt_f32_i32 v144, v144
    v_cvt_f32_i32 v145, v145
    v_cvt_f32_i32 v146, v146
    v_cvt_f32_i32 v147, v147
    v_cvt_f32_i32 v148, v148
    v_cvt_f32_i32 v149, v149
    v_cvt_f32_i32 v150, v150
    v_cvt_f32_i32 v151, v151
    v_cvt_pk_bf16_f32 v250, v128, v129
    v_cvt_pk_bf16_f32 v251, v130, v131
    v_cvt_pk_bf16_f32 v252, v132, v133
    v_cvt_pk_bf16_f32 v253, v134, v135
    buffer_store_dwordx4 v[250:253], v45, s[92:95], s14 offen sc1
    v_cvt_pk_bf16_f32 v144, 0, v144
    v_cvt_pk_bf16_f32 v145, 0, v145
    v_cvt_pk_bf16_f32 v146, 0, v146
    v_cvt_pk_bf16_f32 v147, 0, v147
    v_cvt_pk_bf16_f32 v148, 0, v148
    v_cvt_pk_bf16_f32 v149, 0, v149
    v_cvt_pk_bf16_f32 v150, 0, v150
    v_cvt_pk_bf16_f32 v151, 0, v151
    v_lshlrev_b32 v128, 16, v156
    v_and_b32 v129, 0xffff0000, v156
    v_lshlrev_b32 v136, 16, v152
    v_and_b32 v137, 0xffff0000, v152
    v_lshlrev_b32 v130, 16, v157
    v_and_b32 v131, 0xffff0000, v157
    v_lshlrev_b32 v138, 16, v153
    v_and_b32 v139, 0xffff0000, v153
    v_lshlrev_b32 v132, 16, v158
    v_and_b32 v133, 0xffff0000, v158
    v_lshlrev_b32 v140, 16, v154
    v_and_b32 v141, 0xffff0000, v154
    v_lshlrev_b32 v134, 16, v159
    v_and_b32 v135, 0xffff0000, v159
    v_lshlrev_b32 v142, 16, v155
    v_and_b32 v143, 0xffff0000, v155
    v_sub_f32 v144, v144, v128
    v_sub_f32 v145, v145, v129
    v_sub_f32 v146, v146, v130
    v_sub_f32 v147, v147, v131
    v_sub_f32 v148, v148, v132
    v_sub_f32 v149, v149, v133
    v_sub_f32 v150, v150, v134
    v_sub_f32 v151, v151, v135
    v_cvt_pk_bf16_f32 v144, 0, v144
    v_cvt_pk_bf16_f32 v145, 0, v145
    v_cvt_pk_bf16_f32 v146, 0, v146
    v_cvt_pk_bf16_f32 v147, 0, v147
    v_cvt_pk_bf16_f32 v148, 0, v148
    v_cvt_pk_bf16_f32 v149, 0, v149
    v_cvt_pk_bf16_f32 v150, 0, v150
    v_cvt_pk_bf16_f32 v151, 0, v151
    v_mul_f32 v144, v144, v136
    v_mul_f32 v145, v145, v137
    v_mul_f32 v146, v146, v138
    v_mul_f32 v147, v147, v139
    v_mul_f32 v148, v148, v140
    v_mul_f32 v149, v149, v141
    v_mul_f32 v150, v150, v142
    v_mul_f32 v151, v151, v143
    v_cvt_pk_bf16_f32 v56, v144, v145
    v_cvt_pk_bf16_f32 v57, v146, v147
    v_cvt_pk_bf16_f32 v58, v148, v149
    v_cvt_pk_bf16_f32 v59, v150, v151
    buffer_store_dwordx4 v[56:59], v49, s[92:95], s14 offen sc1
    s_add_u32 m0, s16, 0x1800
    s_add_u32 s13, s19, 0x0
    buffer_load_dwordx4 v42, s[48:51], s13 offen lds
    s_add_u32 m0, s16, 0x1c00
    s_add_u32 s13, s19, 0x100
    buffer_load_dwordx4 v42, s[48:51], s13 offen lds
    s_add_u32 m0, s16, 0x2800
    s_add_u32 s13, s19, 0x0
    buffer_load_dwordx4 v46, s[60:63], s13 offen lds
    s_add_u32 m0, s16, 0x2c00
    s_add_u32 s13, s19, 0x1000
    buffer_load_dwordx4 v46, s[60:63], s13 offen lds
    s_waitcnt vmcnt(4)
    s_lshl_b32 s14, s18, 1
    s_mov_b64 exec, 1
    buffer_store_dwordx2 v[52:53], v50, s[92:95], s14 offen offset:0 sc1
    s_mov_b64 exec, -1
    s_add_u32 m0, s16, 0x3000
    s_add_u32 s13, s20, 0x0
    buffer_load_dwordx4 v42, s[48:51], s13 offen lds
    s_add_u32 m0, s16, 0x3400
    s_add_u32 s13, s20, 0x100
    buffer_load_dwordx4 v42, s[48:51], s13 offen lds
    s_add_u32 m0, s16, 0x4000
    s_add_u32 s13, s20, 0x0
    buffer_load_dwordx4 v46, s[60:63], s13 offen lds
    s_add_u32 m0, s16, 0x4400
    s_add_u32 s13, s20, 0x1000
    buffer_load_dwordx4 v46, s[60:63], s13 offen lds
    s_add_u32 m0, s16, 0x4800
    s_add_u32 s13, s21, 0x0
    buffer_load_dwordx4 v42, s[48:51], s13 offen lds
    s_add_u32 m0, s16, 0x4c00
    s_add_u32 s13, s21, 0x100
    buffer_load_dwordx4 v42, s[48:51], s13 offen lds
    s_add_u32 m0, s16, 0x5800
    s_add_u32 s13, s21, 0x0
    buffer_load_dwordx4 v46, s[60:63], s13 offen lds
    s_add_u32 m0, s16, 0x5c00
    s_add_u32 s13, s21, 0x1000
    buffer_load_dwordx4 v46, s[60:63], s13 offen lds
    v_perm_b32 v164, v68, v64, s98
    v_perm_b32 v172, v80, v72, s98
    v_perm_b32 v180, v76, v84, s98
    v_perm_b32 v165, v68, v64, s99
    v_perm_b32 v173, v80, v72, s99
    v_perm_b32 v181, v76, v84, s99
    v_perm_b32 v166, v69, v65, s98
    v_perm_b32 v174, v81, v73, s98
    v_perm_b32 v182, v77, v85, s98
    v_perm_b32 v167, v69, v65, s99
    v_perm_b32 v175, v81, v73, s99
    v_perm_b32 v183, v77, v85, s99
    v_perm_b32 v168, v70, v66, s98
    v_perm_b32 v176, v82, v74, s98
    v_perm_b32 v184, v78, v86, s98
    v_perm_b32 v169, v70, v66, s99
    v_perm_b32 v177, v82, v74, s99
    v_perm_b32 v185, v78, v86, s99
    v_perm_b32 v170, v71, v67, s98
    v_perm_b32 v178, v83, v75, s98
    v_perm_b32 v186, v79, v87, s98
    v_perm_b32 v171, v71, v67, s99
    v_perm_b32 v179, v83, v75, s99
    v_perm_b32 v187, v79, v87, s99
    v_dot2_f32_bf16 v188, v164, v172, 0 neg_hi:[0,1,0]
    v_dot2_f32_bf16 v189, v165, v173, 0 neg_hi:[0,1,0]
    v_dot2_f32_bf16 v190, v166, v174, 0 neg_hi:[0,1,0]
    v_dot2_f32_bf16 v191, v167, v175, 0 neg_hi:[0,1,0]
    v_dot2_f32_bf16 v192, v168, v176, 0 neg_hi:[0,1,0]
    v_dot2_f32_bf16 v193, v169, v177, 0 neg_hi:[0,1,0]
    v_dot2_f32_bf16 v194, v170, v178, 0 neg_hi:[0,1,0]
    v_dot2_f32_bf16 v195, v171, v179, 0 neg_hi:[0,1,0]
    v_dot2_f32_bf16 v196, v164, v180, 0
    v_dot2_f32_bf16 v197, v165, v181, 0
    v_dot2_f32_bf16 v198, v166, v182, 0
    v_dot2_f32_bf16 v199, v167, v183, 0
    v_dot2_f32_bf16 v200, v168, v184, 0
    v_dot2_f32_bf16 v201, v169, v185, 0
    v_dot2_f32_bf16 v202, v170, v186, 0
    v_dot2_f32_bf16 v203, v171, v187, 0
    v_mul_f32 v188, s100, v188
    v_mul_f32 v189, s100, v189
    v_mul_f32 v190, s100, v190
    v_mul_f32 v191, s100, v191
    v_mul_f32 v192, s100, v192
    v_mul_f32 v193, s100, v193
    v_mul_f32 v194, s100, v194
    v_mul_f32 v195, s100, v195
    v_mul_f32 v196, s100, v196
    v_mul_f32 v197, s100, v197
    v_mul_f32 v198, s100, v198
    v_mul_f32 v199, s100, v199
    v_mul_f32 v200, s100, v200
    v_mul_f32 v201, s100, v201
    v_mul_f32 v202, s100, v202
    v_mul_f32 v203, s100, v203
    v_cvt_pk_bf16_f32 v64, v188, v189
    v_cvt_pk_bf16_f32 v65, v190, v191
    v_cvt_pk_bf16_f32 v66, v196, v197
    v_cvt_pk_bf16_f32 v67, v198, v199
    ds_write_b128 v244, v[64:67] offset:0
    v_cvt_pk_bf16_f32 v68, v192, v193
    v_cvt_pk_bf16_f32 v69, v194, v195
    v_cvt_pk_bf16_f32 v70, v200, v201
    v_cvt_pk_bf16_f32 v71, v202, v203
    ds_write_b128 v244, v[68:71] offset:512
    v_perm_b32 v164, v92, v88, s98
    v_perm_b32 v172, v104, v96, s98
    v_perm_b32 v180, v100, v108, s98
    v_perm_b32 v165, v92, v88, s99
    v_perm_b32 v173, v104, v96, s99
    v_perm_b32 v181, v100, v108, s99
    v_perm_b32 v166, v93, v89, s98
    v_perm_b32 v174, v105, v97, s98
    v_perm_b32 v182, v101, v109, s98
    v_perm_b32 v167, v93, v89, s99
    v_perm_b32 v175, v105, v97, s99
    v_perm_b32 v183, v101, v109, s99
    v_perm_b32 v168, v94, v90, s98
    v_perm_b32 v176, v106, v98, s98
    v_perm_b32 v184, v102, v110, s98
    v_perm_b32 v169, v94, v90, s99
    v_perm_b32 v177, v106, v98, s99
    v_perm_b32 v185, v102, v110, s99
    v_perm_b32 v170, v95, v91, s98
    v_perm_b32 v178, v107, v99, s98
    v_perm_b32 v186, v103, v111, s98
    v_perm_b32 v171, v95, v91, s99
    v_perm_b32 v179, v107, v99, s99
    v_perm_b32 v187, v103, v111, s99
    v_dot2_f32_bf16 v188, v164, v172, 0 neg_hi:[0,1,0]
    v_dot2_f32_bf16 v189, v165, v173, 0 neg_hi:[0,1,0]
    v_dot2_f32_bf16 v190, v166, v174, 0 neg_hi:[0,1,0]
    v_dot2_f32_bf16 v191, v167, v175, 0 neg_hi:[0,1,0]
    v_dot2_f32_bf16 v192, v168, v176, 0 neg_hi:[0,1,0]
    v_dot2_f32_bf16 v193, v169, v177, 0 neg_hi:[0,1,0]
    v_dot2_f32_bf16 v194, v170, v178, 0 neg_hi:[0,1,0]
    v_dot2_f32_bf16 v195, v171, v179, 0 neg_hi:[0,1,0]
    v_dot2_f32_bf16 v196, v164, v180, 0
    v_dot2_f32_bf16 v197, v165, v181, 0
    v_dot2_f32_bf16 v198, v166, v182, 0
    v_dot2_f32_bf16 v199, v167, v183, 0
    v_dot2_f32_bf16 v200, v168, v184, 0
    v_dot2_f32_bf16 v201, v169, v185, 0
    v_dot2_f32_bf16 v202, v170, v186, 0
    v_dot2_f32_bf16 v203, v171, v187, 0
    v_mul_f32 v188, s100, v188
    v_mul_f32 v189, s100, v189
    v_mul_f32 v190, s100, v190
    v_mul_f32 v191, s100, v191
    v_mul_f32 v192, s100, v192
    v_mul_f32 v193, s100, v193
    v_mul_f32 v194, s100, v194
    v_mul_f32 v195, s100, v195
    v_mul_f32 v196, s100, v196
    v_mul_f32 v197, s100, v197
    v_mul_f32 v198, s100, v198
    v_mul_f32 v199, s100, v199
    v_mul_f32 v200, s100, v200
    v_mul_f32 v201, s100, v201
    v_mul_f32 v202, s100, v202
    v_mul_f32 v203, s100, v203
    v_cvt_pk_bf16_f32 v88, v188, v189
    v_cvt_pk_bf16_f32 v89, v190, v191
    v_cvt_pk_bf16_f32 v90, v196, v197
    v_cvt_pk_bf16_f32 v91, v198, v199
    ds_write_b128 v244, v[88:91] offset:128
    v_cvt_pk_bf16_f32 v92, v192, v193
    v_cvt_pk_bf16_f32 v93, v194, v195
    v_cvt_pk_bf16_f32 v94, v200, v201
    v_cvt_pk_bf16_f32 v95, v202, v203
    ds_write_b128 v244, v[92:95] offset:640
    s_waitcnt vmcnt(11)
    ds_read_u16 v40, v209 offset:24608
    ds_read_u16 v41, v209 offset:24864
    ds_read_b128 v[8:11], v208 offset:6144
    ds_read_b128 v[12:15], v208 offset:7168
    ds_read_b64 v[16:17], v47 offset:2048
    ds_read_b64 v[18:19], v47 offset:2560
    ds_read_b64 v[20:21], v47 offset:3072
    ds_read_b64 v[22:23], v47 offset:3584
    ds_read_b64 v[32:33], v210 offset:25120
    ds_read_b64 v[34:35], v210 offset:25136
    ds_read_b64 v[36:37], v210 offset:25376
    ds_read_b64 v[38:39], v210 offset:25392
    s_lshl_b32 s14, s19, 1
    s_add_u32 s14, s14, 0x40000
    s_waitcnt lgkmcnt(8)
    v_lshlrev_b32 v40, 16, v40
    v_lshlrev_b32 v41, 16, v41
    v_cvt_f32_i32 v8, v8
    v_cvt_f32_i32 v9, v9
    v_cvt_f32_i32 v10, v10
    v_cvt_f32_i32 v11, v11
    v_cvt_f32_i32 v12, v12
    v_cvt_f32_i32 v13, v13
    v_cvt_f32_i32 v14, v14
    v_cvt_f32_i32 v15, v15
    v_cvt_pk_bf16_f32 v8, 0, v8
    v_cvt_pk_bf16_f32 v9, 0, v9
    v_cvt_pk_bf16_f32 v10, 0, v10
    v_cvt_pk_bf16_f32 v11, 0, v11
    v_cvt_pk_bf16_f32 v12, 0, v12
    v_cvt_pk_bf16_f32 v13, 0, v13
    v_cvt_pk_bf16_f32 v14, 0, v14
    v_cvt_pk_bf16_f32 v15, 0, v15
    v_sub_f32 v8, v8, v41
    v_sub_f32 v9, v9, v41
    v_sub_f32 v10, v10, v41
    v_sub_f32 v11, v11, v41
    v_sub_f32 v12, v12, v41
    v_sub_f32 v13, v13, v41
    v_sub_f32 v14, v14, v41
    v_sub_f32 v15, v15, v41
    v_cvt_pk_bf16_f32 v8, 0, v8
    v_cvt_pk_bf16_f32 v9, 0, v9
    v_cvt_pk_bf16_f32 v10, 0, v10
    v_cvt_pk_bf16_f32 v11, 0, v11
    v_cvt_pk_bf16_f32 v12, 0, v12
    v_cvt_pk_bf16_f32 v13, 0, v13
    v_cvt_pk_bf16_f32 v14, 0, v14
    v_cvt_pk_bf16_f32 v15, 0, v15
    v_mul_f32 v8, v8, v40
    v_mul_f32 v9, v9, v40
    v_mul_f32 v10, v10, v40
    v_mul_f32 v11, v11, v40
    v_mul_f32 v12, v12, v40
    v_mul_f32 v13, v13, v40
    v_mul_f32 v14, v14, v40
    v_mul_f32 v15, v15, v40
    v_cvt_pk_bf16_f32 v246, v8, v12
    v_cvt_pk_bf16_f32 v247, v9, v13
    v_cvt_pk_bf16_f32 v248, v10, v14
    v_cvt_pk_bf16_f32 v249, v11, v15
    s_waitcnt vmcnt(9)
    ds_read_b32 v24, v48 offset:10240
    ds_read_b32 v25, v48 offset:10368
    ds_read_b32 v26, v48 offset:10496
    ds_read_b32 v27, v48 offset:10624
    ds_read_b32 v28, v48 offset:11264
    ds_read_b32 v29, v48 offset:11392
    ds_read_b32 v30, v48 offset:11520
    ds_read_b32 v31, v48 offset:11648
    s_waitcnt lgkmcnt(12)
    v_perm_b32 v56, v20, v16, s98
    v_perm_b32 v60, v18, v22, s98
    v_perm_b32 v57, v20, v16, s99
    v_perm_b32 v61, v18, v22, s99
    v_perm_b32 v58, v21, v17, s98
    v_perm_b32 v62, v19, v23, s98
    v_perm_b32 v59, v21, v17, s99
    v_perm_b32 v63, v19, v23, s99
    v_dot2_f32_bf16 v8, v246, v56, 0 neg_hi:[0,1,0]
    v_dot2_f32_bf16 v9, v247, v57, 0 neg_hi:[0,1,0]
    v_dot2_f32_bf16 v10, v248, v58, 0 neg_hi:[0,1,0]
    v_dot2_f32_bf16 v11, v249, v59, 0 neg_hi:[0,1,0]
    v_dot2_f32_bf16 v12, v246, v60, 0
    v_dot2_f32_bf16 v13, v247, v61, 0
    v_dot2_f32_bf16 v14, v248, v62, 0
    v_dot2_f32_bf16 v15, v249, v63, 0
    s_waitcnt lgkmcnt(0)
    v_cvt_f32_i32 v24, v24
    v_cvt_f32_i32 v25, v25
    v_cvt_f32_i32 v26, v26
    v_cvt_f32_i32 v27, v27
    v_cvt_f32_i32 v28, v28
    v_cvt_f32_i32 v29, v29
    v_cvt_f32_i32 v30, v30
    v_cvt_f32_i32 v31, v31
    v_cvt_pk_bf16_f32 v250, v8, v9
    v_cvt_pk_bf16_f32 v251, v10, v11
    v_cvt_pk_bf16_f32 v252, v12, v13
    v_cvt_pk_bf16_f32 v253, v14, v15
    buffer_store_dwordx4 v[250:253], v45, s[92:95], s14 offen sc1
    v_cvt_pk_bf16_f32 v24, 0, v24
    v_cvt_pk_bf16_f32 v25, 0, v25
    v_cvt_pk_bf16_f32 v26, 0, v26
    v_cvt_pk_bf16_f32 v27, 0, v27
    v_cvt_pk_bf16_f32 v28, 0, v28
    v_cvt_pk_bf16_f32 v29, 0, v29
    v_cvt_pk_bf16_f32 v30, 0, v30
    v_cvt_pk_bf16_f32 v31, 0, v31
    v_lshlrev_b32 v8, 16, v36
    v_and_b32 v9, 0xffff0000, v36
    v_lshlrev_b32 v16, 16, v32
    v_and_b32 v17, 0xffff0000, v32
    v_lshlrev_b32 v10, 16, v37
    v_and_b32 v11, 0xffff0000, v37
    v_lshlrev_b32 v18, 16, v33
    v_and_b32 v19, 0xffff0000, v33
    v_lshlrev_b32 v12, 16, v38
    v_and_b32 v13, 0xffff0000, v38
    v_lshlrev_b32 v20, 16, v34
    v_and_b32 v21, 0xffff0000, v34
    v_lshlrev_b32 v14, 16, v39
    v_and_b32 v15, 0xffff0000, v39
    v_lshlrev_b32 v22, 16, v35
    v_and_b32 v23, 0xffff0000, v35
    v_sub_f32 v24, v24, v8
    v_sub_f32 v25, v25, v9
    v_sub_f32 v26, v26, v10
    v_sub_f32 v27, v27, v11
    v_sub_f32 v28, v28, v12
    v_sub_f32 v29, v29, v13
    v_sub_f32 v30, v30, v14
    v_sub_f32 v31, v31, v15
    v_cvt_pk_bf16_f32 v24, 0, v24
    v_cvt_pk_bf16_f32 v25, 0, v25
    v_cvt_pk_bf16_f32 v26, 0, v26
    v_cvt_pk_bf16_f32 v27, 0, v27
    v_cvt_pk_bf16_f32 v28, 0, v28
    v_cvt_pk_bf16_f32 v29, 0, v29
    v_cvt_pk_bf16_f32 v30, 0, v30
    v_cvt_pk_bf16_f32 v31, 0, v31
    v_mul_f32 v24, v24, v16
    v_mul_f32 v25, v25, v17
    v_mul_f32 v26, v26, v18
    v_mul_f32 v27, v27, v19
    v_mul_f32 v28, v28, v20
    v_mul_f32 v29, v29, v21
    v_mul_f32 v30, v30, v22
    v_mul_f32 v31, v31, v23
    v_cvt_pk_bf16_f32 v56, v24, v25
    v_cvt_pk_bf16_f32 v57, v26, v27
    v_cvt_pk_bf16_f32 v58, v28, v29
    v_cvt_pk_bf16_f32 v59, v30, v31
    buffer_store_dwordx4 v[56:59], v49, s[92:95], s14 offen sc1
    s_waitcnt lgkmcnt(0)
    s_barrier
    ds_read_b128 v[64:67], v245 offset:0
    ds_read_b128 v[68:71], v245 offset:1040
    ds_read_b128 v[72:75], v245 offset:2080
    ds_read_b128 v[76:79], v245 offset:3120
    ds_read_b128 v[80:83], v245 offset:4160
    ds_read_b128 v[84:87], v245 offset:5200
    ds_read_b128 v[88:91], v245 offset:6240
    ds_read_b128 v[92:95], v245 offset:7280
    ds_read_b128 v[96:99], v245 offset:8320
    ds_read_b128 v[100:103], v245 offset:9360
    ds_read_b128 v[104:107], v245 offset:10400
    ds_read_b128 v[108:111], v245 offset:11440
    ds_read_b128 v[112:115], v245 offset:12480
    ds_read_b128 v[116:119], v245 offset:13520
    ds_read_b128 v[120:123], v245 offset:14560
    ds_read_b128 v[124:127], v245 offset:15600
    buffer_load_dwordx2 v[54:55], v51, s[92:95], 0 offen offset:0 sc1
    s_waitcnt vmcnt(9)
    ds_read_u16 v40, v209 offset:24640
    ds_read_u16 v41, v209 offset:24896
    ds_read_b128 v[8:11], v208 offset:12288
    ds_read_b128 v[12:15], v208 offset:13312
    ds_read_b64 v[16:17], v47 offset:2048
    ds_read_b64 v[18:19], v47 offset:2560
    ds_read_b64 v[20:21], v47 offset:3072
    ds_read_b64 v[22:23], v47 offset:3584
    ds_read_b64 v[32:33], v210 offset:25152
    ds_read_b64 v[34:35], v210 offset:25168
    ds_read_b64 v[36:37], v210 offset:25408
    ds_read_b64 v[38:39], v210 offset:25424
    s_lshl_b32 s14, s20, 1
    s_add_u32 s14, s14, 0x80000
    s_waitcnt lgkmcnt(8)
    v_lshlrev_b32 v40, 16, v40
    v_lshlrev_b32 v41, 16, v41
    v_cvt_f32_i32 v8, v8
    v_cvt_f32_i32 v9, v9
    v_cvt_f32_i32 v10, v10
    v_cvt_f32_i32 v11, v11
    v_cvt_f32_i32 v12, v12
    v_cvt_f32_i32 v13, v13
    v_cvt_f32_i32 v14, v14
    v_cvt_f32_i32 v15, v15
    v_cvt_pk_bf16_f32 v8, 0, v8
    v_cvt_pk_bf16_f32 v9, 0, v9
    v_cvt_pk_bf16_f32 v10, 0, v10
    v_cvt_pk_bf16_f32 v11, 0, v11
    v_cvt_pk_bf16_f32 v12, 0, v12
    v_cvt_pk_bf16_f32 v13, 0, v13
    v_cvt_pk_bf16_f32 v14, 0, v14
    v_cvt_pk_bf16_f32 v15, 0, v15
    v_sub_f32 v8, v8, v41
    v_sub_f32 v9, v9, v41
    v_sub_f32 v10, v10, v41
    v_sub_f32 v11, v11, v41
    v_sub_f32 v12, v12, v41
    v_sub_f32 v13, v13, v41
    v_sub_f32 v14, v14, v41
    v_sub_f32 v15, v15, v41
    v_cvt_pk_bf16_f32 v8, 0, v8
    v_cvt_pk_bf16_f32 v9, 0, v9
    v_cvt_pk_bf16_f32 v10, 0, v10
    v_cvt_pk_bf16_f32 v11, 0, v11
    v_cvt_pk_bf16_f32 v12, 0, v12
    v_cvt_pk_bf16_f32 v13, 0, v13
    v_cvt_pk_bf16_f32 v14, 0, v14
    v_cvt_pk_bf16_f32 v15, 0, v15
    v_mul_f32 v8, v8, v40
    v_mul_f32 v9, v9, v40
    v_mul_f32 v10, v10, v40
    v_mul_f32 v11, v11, v40
    v_mul_f32 v12, v12, v40
    v_mul_f32 v13, v13, v40
    v_mul_f32 v14, v14, v40
    v_mul_f32 v15, v15, v40
    v_cvt_pk_bf16_f32 v246, v8, v12
    v_cvt_pk_bf16_f32 v247, v9, v13
    v_cvt_pk_bf16_f32 v248, v10, v14
    v_cvt_pk_bf16_f32 v249, v11, v15
    s_waitcnt vmcnt(7)
    ds_read_b32 v24, v48 offset:16384
    ds_read_b32 v25, v48 offset:16512
    ds_read_b32 v26, v48 offset:16640
    ds_read_b32 v27, v48 offset:16768
    ds_read_b32 v28, v48 offset:17408
    ds_read_b32 v29, v48 offset:17536
    ds_read_b32 v30, v48 offset:17664
    ds_read_b32 v31, v48 offset:17792
    s_waitcnt lgkmcnt(12)
    v_perm_b32 v56, v20, v16, s98
    v_perm_b32 v60, v18, v22, s98
    v_perm_b32 v57, v20, v16, s99
    v_perm_b32 v61, v18, v22, s99
    v_perm_b32 v58, v21, v17, s98
    v_perm_b32 v62, v19, v23, s98
    v_perm_b32 v59, v21, v17, s99
    v_perm_b32 v63, v19, v23, s99
    v_dot2_f32_bf16 v8, v246, v56, 0 neg_hi:[0,1,0]
    v_dot2_f32_bf16 v9, v247, v57, 0 neg_hi:[0,1,0]
    v_dot2_f32_bf16 v10, v248, v58, 0 neg_hi:[0,1,0]
    v_dot2_f32_bf16 v11, v249, v59, 0 neg_hi:[0,1,0]
    v_dot2_f32_bf16 v12, v246, v60, 0
    v_dot2_f32_bf16 v13, v247, v61, 0
    v_dot2_f32_bf16 v14, v248, v62, 0
    v_dot2_f32_bf16 v15, v249, v63, 0
    s_waitcnt lgkmcnt(0)
    v_cvt_f32_i32 v24, v24
    v_cvt_f32_i32 v25, v25
    v_cvt_f32_i32 v26, v26
    v_cvt_f32_i32 v27, v27
    v_cvt_f32_i32 v28, v28
    v_cvt_f32_i32 v29, v29
    v_cvt_f32_i32 v30, v30
    v_cvt_f32_i32 v31, v31
    v_cvt_pk_bf16_f32 v212, v8, v9
    v_cvt_pk_bf16_f32 v213, v10, v11
    v_cvt_pk_bf16_f32 v214, v12, v13
    v_cvt_pk_bf16_f32 v215, v14, v15
    v_cvt_pk_bf16_f32 v24, 0, v24
    v_cvt_pk_bf16_f32 v25, 0, v25
    v_cvt_pk_bf16_f32 v26, 0, v26
    v_cvt_pk_bf16_f32 v27, 0, v27
    v_cvt_pk_bf16_f32 v28, 0, v28
    v_cvt_pk_bf16_f32 v29, 0, v29
    v_cvt_pk_bf16_f32 v30, 0, v30
    v_cvt_pk_bf16_f32 v31, 0, v31
    v_lshlrev_b32 v8, 16, v36
    v_and_b32 v9, 0xffff0000, v36
    v_lshlrev_b32 v16, 16, v32
    v_and_b32 v17, 0xffff0000, v32
    v_lshlrev_b32 v10, 16, v37
    v_and_b32 v11, 0xffff0000, v37
    v_lshlrev_b32 v18, 16, v33
    v_and_b32 v19, 0xffff0000, v33
    v_lshlrev_b32 v12, 16, v38
    v_and_b32 v13, 0xffff0000, v38
    v_lshlrev_b32 v20, 16, v34
    v_and_b32 v21, 0xffff0000, v34
    v_lshlrev_b32 v14, 16, v39
    v_and_b32 v15, 0xffff0000, v39
    v_lshlrev_b32 v22, 16, v35
    v_and_b32 v23, 0xffff0000, v35
    v_sub_f32 v24, v24, v8
    v_sub_f32 v25, v25, v9
    v_sub_f32 v26, v26, v10
    v_sub_f32 v27, v27, v11
    v_sub_f32 v28, v28, v12
    v_sub_f32 v29, v29, v13
    v_sub_f32 v30, v30, v14
    v_sub_f32 v31, v31, v15
    v_cvt_pk_bf16_f32 v24, 0, v24
    v_cvt_pk_bf16_f32 v25, 0, v25
    v_cvt_pk_bf16_f32 v26, 0, v26
    v_cvt_pk_bf16_f32 v27, 0, v27
    v_cvt_pk_bf16_f32 v28, 0, v28
    v_cvt_pk_bf16_f32 v29, 0, v29
    v_cvt_pk_bf16_f32 v30, 0, v30
    v_cvt_pk_bf16_f32 v31, 0, v31
    v_mul_f32 v24, v24, v16
    v_mul_f32 v25, v25, v17
    v_mul_f32 v26, v26, v18
    v_mul_f32 v27, v27, v19
    v_mul_f32 v28, v28, v20
    v_mul_f32 v29, v29, v21
    v_mul_f32 v30, v30, v22
    v_mul_f32 v31, v31, v23
    v_cvt_pk_bf16_f32 v216, v24, v25
    v_cvt_pk_bf16_f32 v217, v26, v27
    v_cvt_pk_bf16_f32 v218, v28, v29
    v_cvt_pk_bf16_f32 v219, v30, v31
    s_waitcnt vmcnt(0)
    v_cmp_ne_u64 vcc, s[96:97], v[54:55]
    s_cbranch_vccnz L_spin_0
L_spinret_0:
    s_add_u32 s7, s9, 0x0
    buffer_load_dwordx4 a[128:131], v4, s[92:95], s7 offen offset:0 sc1
    buffer_load_dwordx4 a[132:135], v4, s[92:95], s7 offen offset:1024 sc1
    buffer_load_dwordx4 a[136:139], v4, s[92:95], s7 offen offset:2048 sc1
    buffer_load_dwordx4 a[140:143], v4, s[92:95], s7 offen offset:3072 sc1
    buffer_load_dwordx4 a[144:147], v5, s[92:95], s7 offen offset:0 sc1
    buffer_load_dwordx4 a[148:151], v5, s[92:95], s7 offen offset:1024 sc1
    buffer_load_dwordx4 a[152:155], v5, s[92:95], s7 offen offset:2048 sc1
    buffer_load_dwordx4 a[156:159], v5, s[92:95], s7 offen offset:3072 sc1
    s_add_u32 s8, s9, 0x0
    buffer_load_dwordx4 a[192:195], v6, s[92:95], s8 offen offset:0 sc1
    buffer_load_dwordx4 a[196:199], v6, s[92:95], s8 offen offset:1024 sc1
    buffer_load_dwordx4 a[200:203], v6, s[92:95], s8 offen offset:2048 sc1
    buffer_load_dwordx4 a[204:207], v6, s[92:95], s8 offen offset:3072 sc1
    buffer_load_dwordx4 a[208:211], v7, s[92:95], s8 offen offset:0 sc1
    buffer_load_dwordx4 a[212:215], v7, s[92:95], s8 offen offset:1024 sc1
    buffer_load_dwordx4 a[216:219], v7, s[92:95], s8 offen offset:2048 sc1
    buffer_load_dwordx4 a[220:223], v7, s[92:95], s8 offen offset:3072 sc1
    s_add_u32 s7, s10, 0x0
    buffer_load_dwordx4 a[160:163], v4, s[92:95], s7 offen offset:0 sc1
    buffer_load_dwordx4 a[164:167], v4, s[92:95], s7 offen offset:1024 sc1
    buffer_load_dwordx4 a[168:171], v4, s[92:95], s7 offen offset:2048 sc1
    buffer_load_dwordx4 a[172:175], v4, s[92:95], s7 offen offset:3072 sc1
    buffer_load_dwordx4 a[176:179], v5, s[92:95], s7 offen offset:0 sc1
    buffer_load_dwordx4 a[180:183], v5, s[92:95], s7 offen offset:1024 sc1
    buffer_load_dwordx4 a[184:187], v5, s[92:95], s7 offen offset:2048 sc1
    buffer_load_dwordx4 a[188:191], v5, s[92:95], s7 offen offset:3072 sc1
    s_add_u32 s8, s10, 0x0
    buffer_load_dwordx4 a[224:227], v6, s[92:95], s8 offen offset:0 sc1
    buffer_load_dwordx4 a[228:231], v6, s[92:95], s8 offen offset:1024 sc1
    buffer_load_dwordx4 a[232:235], v6, s[92:95], s8 offen offset:2048 sc1
    buffer_load_dwordx4 a[236:239], v6, s[92:95], s8 offen offset:3072 sc1
    buffer_load_dwordx4 a[240:243], v7, s[92:95], s8 offen offset:0 sc1
    buffer_load_dwordx4 a[244:247], v7, s[92:95], s8 offen offset:1024 sc1
    buffer_load_dwordx4 a[248:251], v7, s[92:95], s8 offen offset:2048 sc1
    buffer_load_dwordx4 a[252:255], v7, s[92:95], s8 offen offset:3072 sc1
    s_lshl_b32 s14, s20, 1
    s_add_u32 s14, s14, 0x80000
    buffer_store_dwordx4 v[212:215], v45, s[92:95], s14 offen sc1
    buffer_store_dwordx4 v[216:219], v49, s[92:95], s14 offen sc1
    s_lshl_b32 s14, s19, 1
    s_mov_b64 exec, 1
    buffer_store_dwordx2 v[52:53], v50, s[92:95], s14 offen offset:1024 sc1
    s_mov_b64 exec, -1
    v_mov_b32 v242, 0
    v_mov_b32 v243, 0
    s_waitcnt lgkmcnt(0)
    s_waitcnt vmcnt(27)
    v_mfma_f32_32x32x16_bf16 v[128:143], a[128:131], v[64:67], 0
    v_mfma_f32_32x32x16_bf16 v[128:143], a[132:135], v[68:71], v[128:143]
    v_mfma_f32_32x32x16_bf16 v[128:143], a[136:139], v[72:75], v[128:143]
    v_mfma_f32_32x32x16_bf16 v[128:143], a[140:143], v[76:79], v[128:143]
    v_mfma_f32_32x32x16_bf16 v[128:143], a[144:147], v[80:83], v[128:143]
    v_mfma_f32_32x32x16_bf16 v[128:143], a[148:151], v[84:87], v[128:143]
    v_mfma_f32_32x32x16_bf16 v[128:143], a[152:155], v[88:91], v[128:143]
    v_mfma_f32_32x32x16_bf16 v[128:143], a[156:159], v[92:95], v[128:143]
    v_mfma_f32_32x32x16_bf16 v[144:159], a[128:131], v[96:99], 0
    v_mfma_f32_32x32x16_bf16 v[144:159], a[132:135], v[100:103], v[144:159]
    v_mfma_f32_32x32x16_bf16 v[144:159], a[136:139], v[104:107], v[144:159]
    v_mfma_f32_32x32x16_bf16 v[144:159], a[140:143], v[108:111], v[144:159]
    v_mfma_f32_32x32x16_bf16 v[144:159], a[144:147], v[112:115], v[144:159]
    v_mfma_f32_32x32x16_bf16 v[144:159], a[148:151], v[116:119], v[144:159]
    v_mfma_f32_32x32x16_bf16 v[144:159], a[152:155], v[120:123], v[144:159]
    v_mfma_f32_32x32x16_bf16 v[144:159], a[156:159], v[124:127], v[144:159]
    s_nop 3
    v_max3_f32 v246, v128, v129, v130
    v_max3_f32 v246, v246, v131, v132
    v_max3_f32 v246, v246, v133, v134
    v_max3_f32 v246, v246, v135, v136
    v_max3_f32 v246, v246, v137, v138
    v_max3_f32 v246, v246, v139, v140
    v_max3_f32 v246, v246, v141, v142
    v_max_f32 v246, v246, v143
    v_mov_b32 v247, v246
    s_nop 1
    v_permlane32_swap_b32 v246, v247
    s_nop 1
    v_max_f32 v244, v246, v247
    v_sub_f32 v246, 0, v244
    v_add_f32 v128, v128, v246
    v_add_f32 v129, v129, v246
    v_add_f32 v130, v130, v246
    v_add_f32 v131, v131, v246
    v_add_f32 v132, v132, v246
    v_add_f32 v133, v133, v246
    v_add_f32 v134, v134, v246
    v_add_f32 v135, v135, v246
    v_add_f32 v136, v136, v246
    v_add_f32 v137, v137, v246
    v_add_f32 v138, v138, v246
    v_add_f32 v139, v139, v246
    v_add_f32 v140, v140, v246
    v_add_f32 v141, v141, v246
    v_add_f32 v142, v142, v246
    v_add_f32 v143, v143, v246
    v_mov_b32 v160, v246
    v_mov_b32 v161, v246
    v_mov_b32 v162, v246
    v_mov_b32 v163, v246
    v_mov_b32 v164, v246
    v_mov_b32 v165, v246
    v_mov_b32 v166, v246
    v_mov_b32 v167, v246
    v_mov_b32 v168, v246
    v_mov_b32 v169, v246
    v_mov_b32 v170, v246
    v_mov_b32 v171, v246
    v_mov_b32 v172, v246
    v_mov_b32 v173, v246
    v_mov_b32 v174, v246
    v_mov_b32 v175, v246
    v_exp_f32 v192, v128
    v_exp_f32 v193, v129
    v_exp_f32 v194, v130
    v_add_f32 v240, v192, v193
    v_exp_f32 v195, v131
    v_add_f32 v240, v240, v194
    v_cvt_pk_bf16_f32 v224, v192, v193
    v_exp_f32 v196, v132
    v_add_f32 v240, v240, v195
    v_exp_f32 v197, v133
    v_add_f32 v240, v240, v196
    v_cvt_pk_bf16_f32 v225, v194, v195
    v_exp_f32 v198, v134
    v_add_f32 v240, v240, v197
    v_exp_f32 v199, v135
    v_add_f32 v240, v240, v198
    v_cvt_pk_bf16_f32 v226, v196, v197
    v_exp_f32 v200, v136
    v_add_f32 v240, v240, v199
    v_exp_f32 v201, v137
    v_add_f32 v240, v240, v200
    v_exp_f32 v202, v138
    v_add_f32 v240, v240, v201
    v_exp_f32 v203, v139
    v_add_f32 v240, v240, v202
    v_exp_f32 v204, v140
    v_add_f32 v240, v240, v203
    v_exp_f32 v205, v141
    v_add_f32 v240, v240, v204
    v_exp_f32 v206, v142
    v_add_f32 v240, v240, v205
    v_exp_f32 v207, v143
    v_add_f32 v240, v240, v206
    v_cvt_pk_bf16_f32 v227, v198, v199
    v_add_f32 v240, v240, v207
    v_cmp_lt_f32 vcc, s6, v240
    v_max3_f32 v246, v144, v145, v146
    v_max3_f32 v246, v246, v147, v148
    v_max3_f32 v246, v246, v149, v150
    v_max3_f32 v246, v246, v151, v152
    v_max3_f32 v246, v246, v153, v154
    v_max3_f32 v246, v246, v155, v156
    v_max3_f32 v246, v246, v157, v158
    v_max_f32 v246, v246, v159
    v_mov_b32 v247, v246
    s_nop 1
    v_permlane32_swap_b32 v246, v247
    s_nop 1
    v_max_f32 v245, v246, v247
    v_sub_f32 v246, 0, v245
    v_add_f32 v144, v144, v246
    v_add_f32 v145, v145, v246
    v_add_f32 v146, v146, v246
    v_add_f32 v147, v147, v246
    v_add_f32 v148, v148, v246
    v_add_f32 v149, v149, v246
    v_add_f32 v150, v150, v246
    v_add_f32 v151, v151, v246
    v_add_f32 v152, v152, v246
    v_add_f32 v153, v153, v246
    v_add_f32 v154, v154, v246
    v_add_f32 v155, v155, v246
    v_add_f32 v156, v156, v246
    v_add_f32 v157, v157, v246
    v_add_f32 v158, v158, v246
    v_add_f32 v159, v159, v246
    v_mov_b32 v176, v246
    v_mov_b32 v177, v246
    v_mov_b32 v178, v246
    v_mov_b32 v179, v246
    v_mov_b32 v180, v246
    v_mov_b32 v181, v246
    v_mov_b32 v182, v246
    v_mov_b32 v183, v246
    v_mov_b32 v184, v246
    v_mov_b32 v185, v246
    v_mov_b32 v186, v246
    v_mov_b32 v187, v246
    v_mov_b32 v188, v246
    v_mov_b32 v189, v246
    v_mov_b32 v190, v246
    v_mov_b32 v191, v246
    s_waitcnt vmcnt(19)
    s_add_u32 s7, s11, 0x0
    v_mfma_f32_32x32x16_bf16 a[0:15], a[192:195], v[224:227], a[0:15]
    buffer_load_dwordx4 a[128:131], v4, s[92:95], s7 offen offset:0 sc1
    v_cvt_pk_bf16_f32 v228, v200, v201
    v_cvt_pk_bf16_f32 v229, v202, v203
    v_mfma_f32_32x32x16_bf16 a[16:31], a[196:199], v[224:227], a[16:31]
    buffer_load_dwordx4 a[132:135], v4, s[92:95], s7 offen offset:1024 sc1
    v_cvt_pk_bf16_f32 v230, v204, v205
    v_cvt_pk_bf16_f32 v231, v206, v207
    v_add_f32 v242, v242, v240
    v_mfma_f32_32x32x16_bf16 a[32:47], a[200:203], v[224:227], a[32:47]
    buffer_load_dwordx4 a[136:139], v4, s[92:95], s7 offen offset:2048 sc1
    v_exp_f32 v192, v144
    v_exp_f32 v193, v145
    v_mfma_f32_32x32x16_bf16 a[48:63], a[204:207], v[224:227], a[48:63]
    buffer_load_dwordx4 a[140:143], v4, s[92:95], s7 offen offset:3072 sc1
    v_exp_f32 v194, v146
    v_add_f32 v241, v192, v193
    v_mfma_f32_32x32x16_bf16 a[0:15], a[208:211], v[228:231], a[0:15]
    buffer_load_dwordx4 a[144:147], v5, s[92:95], s7 offen offset:0 sc1
    v_exp_f32 v195, v147
    v_add_f32 v241, v241, v194
    v_mfma_f32_32x32x16_bf16 a[16:31], a[212:215], v[228:231], a[16:31]
    buffer_load_dwordx4 a[148:151], v5, s[92:95], s7 offen offset:1024 sc1
    v_exp_f32 v196, v148
    v_add_f32 v241, v241, v195
    v_mfma_f32_32x32x16_bf16 a[32:47], a[216:219], v[228:231], a[32:47]
    buffer_load_dwordx4 a[152:155], v5, s[92:95], s7 offen offset:2048 sc1
    v_exp_f32 v197, v149
    v_add_f32 v241, v241, v196
    v_mfma_f32_32x32x16_bf16 a[48:63], a[220:223], v[228:231], a[48:63]
    buffer_load_dwordx4 a[156:159], v5, s[92:95], s7 offen offset:3072 sc1
    v_exp_f32 v198, v150
    v_add_f32 v241, v241, v197
    ds_read_u16 v40, v209 offset:24672
    ds_read_u16 v41, v209 offset:24928
    ds_read_b128 v[8:11], v208 offset:18432
    ds_read_b128 v[12:15], v208 offset:19456
    ds_read_b64 v[16:17], v47 offset:2048
    ds_read_b64 v[18:19], v47 offset:2560
    ds_read_b64 v[20:21], v47 offset:3072
    ds_read_b64 v[22:23], v47 offset:3584
    ds_read_b64 v[32:33], v210 offset:25184
    ds_read_b64 v[34:35], v210 offset:25200
    ds_read_b64 v[36:37], v210 offset:25440
    ds_read_b64 v[38:39], v210 offset:25456
    s_lshl_b32 s14, s21, 1
    s_add_u32 s14, s14, 0xc0000
    s_waitcnt lgkmcnt(8)
    v_lshlrev_b32 v40, 16, v40
    v_lshlrev_b32 v41, 16, v41
    v_cvt_f32_i32 v8, v8
    v_cvt_f32_i32 v9, v9
    v_cvt_f32_i32 v10, v10
    v_cvt_f32_i32 v11, v11
    v_cvt_f32_i32 v12, v12
    v_cvt_f32_i32 v13, v13
    v_cvt_f32_i32 v14, v14
    v_cvt_f32_i32 v15, v15
    v_cvt_pk_bf16_f32 v8, 0, v8
    v_cvt_pk_bf16_f32 v9, 0, v9
    v_cvt_pk_bf16_f32 v10, 0, v10
    v_cvt_pk_bf16_f32 v11, 0, v11
    v_cvt_pk_bf16_f32 v12, 0, v12
    v_cvt_pk_bf16_f32 v13, 0, v13
    v_cvt_pk_bf16_f32 v14, 0, v14
    v_cvt_pk_bf16_f32 v15, 0, v15
    v_sub_f32 v8, v8, v41
    v_sub_f32 v9, v9, v41
    v_sub_f32 v10, v10, v41
    v_sub_f32 v11, v11, v41
    v_sub_f32 v12, v12, v41
    v_sub_f32 v13, v13, v41
    v_sub_f32 v14, v14, v41
    v_sub_f32 v15, v15, v41
    v_cvt_pk_bf16_f32 v8, 0, v8
    v_cvt_pk_bf16_f32 v9, 0, v9
    v_cvt_pk_bf16_f32 v10, 0, v10
    v_cvt_pk_bf16_f32 v11, 0, v11
    v_cvt_pk_bf16_f32 v12, 0, v12
    v_cvt_pk_bf16_f32 v13, 0, v13
    v_cvt_pk_bf16_f32 v14, 0, v14
    v_cvt_pk_bf16_f32 v15, 0, v15
    v_mul_f32 v8, v8, v40
    v_mul_f32 v9, v9, v40
    v_mul_f32 v10, v10, v40
    v_mul_f32 v11, v11, v40
    v_mul_f32 v12, v12, v40
    v_mul_f32 v13, v13, v40
    v_mul_f32 v14, v14, v40
    v_mul_f32 v15, v15, v40
    v_cvt_pk_bf16_f32 v246, v8, v12
    v_cvt_pk_bf16_f32 v247, v9, v13
    v_cvt_pk_bf16_f32 v248, v10, v14
    v_cvt_pk_bf16_f32 v249, v11, v15
    ds_read_b32 v24, v48 offset:22528
    ds_read_b32 v25, v48 offset:22656
    ds_read_b32 v26, v48 offset:22784
    ds_read_b32 v27, v48 offset:22912
    ds_read_b32 v28, v48 offset:23552
    ds_read_b32 v29, v48 offset:23680
    ds_read_b32 v30, v48 offset:23808
    ds_read_b32 v31, v48 offset:23936
    s_waitcnt lgkmcnt(12)
    v_perm_b32 v56, v20, v16, s98
    v_perm_b32 v60, v18, v22, s98
    v_perm_b32 v57, v20, v16, s99
    v_perm_b32 v61, v18, v22, s99
    v_perm_b32 v58, v21, v17, s98
    v_perm_b32 v62, v19, v23, s98
    v_perm_b32 v59, v21, v17, s99
    v_perm_b32 v63, v19, v23, s99
    v_dot2_f32_bf16 v8, v246, v56, 0 neg_hi:[0,1,0]
    v_dot2_f32_bf16 v9, v247, v57, 0 neg_hi:[0,1,0]
    v_dot2_f32_bf16 v10, v248, v58, 0 neg_hi:[0,1,0]
    v_dot2_f32_bf16 v11, v249, v59, 0 neg_hi:[0,1,0]
    v_dot2_f32_bf16 v12, v246, v60, 0
    v_dot2_f32_bf16 v13, v247, v61, 0
    v_dot2_f32_bf16 v14, v248, v62, 0
    v_dot2_f32_bf16 v15, v249, v63, 0
    s_waitcnt lgkmcnt(0)
    v_cvt_f32_i32 v24, v24
    v_cvt_f32_i32 v25, v25
    v_cvt_f32_i32 v26, v26
    v_cvt_f32_i32 v27, v27
    v_cvt_f32_i32 v28, v28
    v_cvt_f32_i32 v29, v29
    v_cvt_f32_i32 v30, v30
    v_cvt_f32_i32 v31, v31
    v_cvt_pk_bf16_f32 v250, v8, v9
    v_cvt_pk_bf16_f32 v251, v10, v11
    v_cvt_pk_bf16_f32 v252, v12, v13
    v_cvt_pk_bf16_f32 v253, v14, v15
    buffer_store_dwordx4 v[250:253], v45, s[92:95], s14 offen sc1
    v_cvt_pk_bf16_f32 v24, 0, v24
    v_cvt_pk_bf16_f32 v25, 0, v25
    v_cvt_pk_bf16_f32 v26, 0, v26
    v_cvt_pk_bf16_f32 v27, 0, v27
    v_cvt_pk_bf16_f32 v28, 0, v28
    v_cvt_pk_bf16_f32 v29, 0, v29
    v_cvt_pk_bf16_f32 v30, 0, v30
    v_cvt_pk_bf16_f32 v31, 0, v31
    v_lshlrev_b32 v8, 16, v36
    v_and_b32 v9, 0xffff0000, v36
    v_lshlrev_b32 v16, 16, v32
    v_and_b32 v17, 0xffff0000, v32
    v_lshlrev_b32 v10, 16, v37
    v_and_b32 v11, 0xffff0000, v37
    v_lshlrev_b32 v18, 16, v33
    v_and_b32 v19, 0xffff0000, v33
    v_lshlrev_b32 v12, 16, v38
    v_and_b32 v13, 0xffff0000, v38
    v_lshlrev_b32 v20, 16, v34
    v_and_b32 v21, 0xffff0000, v34
    v_lshlrev_b32 v14, 16, v39
    v_and_b32 v15, 0xffff0000, v39
    v_lshlrev_b32 v22, 16, v35
    v_and_b32 v23, 0xffff0000, v35
    v_sub_f32 v24, v24, v8
    v_sub_f32 v25, v25, v9
    v_sub_f32 v26, v26, v10
    v_sub_f32 v27, v27, v11
    v_sub_f32 v28, v28, v12
    v_sub_f32 v29, v29, v13
    v_sub_f32 v30, v30, v14
    v_sub_f32 v31, v31, v15
    v_cvt_pk_bf16_f32 v24, 0, v24
    v_cvt_pk_bf16_f32 v25, 0, v25
    v_cvt_pk_bf16_f32 v26, 0, v26
    v_cvt_pk_bf16_f32 v27, 0, v27
    v_cvt_pk_bf16_f32 v28, 0, v28
    v_cvt_pk_bf16_f32 v29, 0, v29
    v_cvt_pk_bf16_f32 v30, 0, v30
    v_cvt_pk_bf16_f32 v31, 0, v31
    v_mul_f32 v24, v24, v16
    v_mul_f32 v25, v25, v17
    v_mul_f32 v26, v26, v18
    v_mul_f32 v27, v27, v19
    v_mul_f32 v28, v28, v20
    v_mul_f32 v29, v29, v21
    v_mul_f32 v30, v30, v22
    v_mul_f32 v31, v31, v23
    v_cvt_pk_bf16_f32 v56, v24, v25
    v_cvt_pk_bf16_f32 v57, v26, v27
    v_cvt_pk_bf16_f32 v58, v28, v29
    v_cvt_pk_bf16_f32 v59, v30, v31
    buffer_store_dwordx4 v[56:59], v49, s[92:95], s14 offen sc1
    s_waitcnt vmcnt(25)
    v_mfma_f32_32x32x16_bf16 v[128:143], a[160:163], v[64:67], v[160:175]
    v_exp_f32 v199, v151
    v_exp_f32 v200, v152
    v_add_f32 v241, v241, v198
    v_mfma_f32_32x32x16_bf16 v[128:143], a[164:167], v[68:71], v[128:143]
    v_exp_f32 v201, v153
    v_add_f32 v241, v241, v199
    v_cvt_pk_bf16_f32 v232, v192, v193
    v_mfma_f32_32x32x16_bf16 v[128:143], a[168:171], v[72:75], v[128:143]
    v_exp_f32 v202, v154
    v_exp_f32 v203, v155
    v_add_f32 v241, v241, v200
    v_mfma_f32_32x32x16_bf16 v[128:143], a[172:175], v[76:79], v[128:143]
    v_exp_f32 v204, v156
    v_add_f32 v241, v241, v201
    v_cvt_pk_bf16_f32 v233, v194, v195
    v_add_f32 v241, v241, v202
    s_waitcnt vmcnt(21)
    v_mfma_f32_32x32x16_bf16 v[128:143], a[176:179], v[80:83], v[128:143]
    v_exp_f32 v205, v157
    v_add_f32 v241, v241, v203
    v_cvt_pk_bf16_f32 v234, v196, v197
    v_mfma_f32_32x32x16_bf16 v[128:143], a[180:183], v[84:87], v[128:143]
    v_exp_f32 v206, v158
    v_add_f32 v241, v241, v204
    v_cvt_pk_bf16_f32 v235, v198, v199
    v_add_f32 v241, v241, v205
    v_mfma_f32_32x32x16_bf16 v[128:143], a[184:187], v[88:91], v[128:143]
    v_exp_f32 v207, v159
    v_add_f32 v241, v241, v206
    v_add_f32 v241, v241, v207
    v_cmp_lt_f32 vcc, s6, v241
    v_mfma_f32_32x32x16_bf16 v[128:143], a[188:191], v[92:95], v[128:143]
    s_cbranch_vccnz L_stub_0
L_ret_0:
    s_nop 0
    s_add_u32 s8, s11, 0x0
    v_mfma_f32_32x32x16_bf16 a[64:79], a[192:195], v[232:235], a[64:79]
    buffer_load_dwordx4 a[192:195], v6, s[92:95], s8 offen offset:0 sc1
    v_cvt_pk_bf16_f32 v236, v200, v201
    v_cvt_pk_bf16_f32 v237, v202, v203
    v_mfma_f32_32x32x16_bf16 a[80:95], a[196:199], v[232:235], a[80:95]
    buffer_load_dwordx4 a[196:199], v6, s[92:95], s8 offen offset:1024 sc1
    v_cvt_pk_bf16_f32 v238, v204, v205
    v_cvt_pk_bf16_f32 v239, v206, v207
    v_add_f32 v243, v243, v241
    v_mfma_f32_32x32x16_bf16 a[96:111], a[200:203], v[232:235], a[96:111]
    buffer_load_dwordx4 a[200:203], v6, s[92:95], s8 offen offset:2048 sc1
    v_exp_f32 v192, v128
    v_exp_f32 v193, v129
    v_mfma_f32_32x32x16_bf16 a[112:127], a[204:207], v[232:235], a[112:127]
    buffer_load_dwordx4 a[204:207], v6, s[92:95], s8 offen offset:3072 sc1
    v_exp_f32 v194, v130
    v_add_f32 v240, v192, v193
    v_mfma_f32_32x32x16_bf16 a[64:79], a[208:211], v[236:239], a[64:79]
    buffer_load_dwordx4 a[208:211], v7, s[92:95], s8 offen offset:0 sc1
    v_exp_f32 v195, v131
    v_add_f32 v240, v240, v194
    v_mfma_f32_32x32x16_bf16 a[80:95], a[212:215], v[236:239], a[80:95]
    buffer_load_dwordx4 a[212:215], v7, s[92:95], s8 offen offset:1024 sc1
    v_exp_f32 v196, v132
    v_add_f32 v240, v240, v195
    v_mfma_f32_32x32x16_bf16 a[96:111], a[216:219], v[236:239], a[96:111]
    buffer_load_dwordx4 a[216:219], v7, s[92:95], s8 offen offset:2048 sc1
    v_exp_f32 v197, v133
    v_add_f32 v240, v240, v196
    v_mfma_f32_32x32x16_bf16 a[112:127], a[220:223], v[236:239], a[112:127]
    buffer_load_dwordx4 a[220:223], v7, s[92:95], s8 offen offset:3072 sc1
    v_exp_f32 v198, v134
    v_add_f32 v240, v240, v197
    s_waitcnt vmcnt(19)
    s_lshl_b32 s14, s20, 1
    s_mov_b64 exec, 1
    buffer_store_dwordx2 v[52:53], v50, s[92:95], s14 offen offset:2048 sc1
    s_mov_b64 exec, -1
    v_mfma_f32_32x32x16_bf16 v[144:159], a[160:163], v[96:99], v[176:191]
    v_exp_f32 v199, v135
    v_exp_f32 v200, v136
    v_add_f32 v240, v240, v198
    v_mfma_f32_32x32x16_bf16 v[144:159], a[164:167], v[100:103], v[144:159]
    v_exp_f32 v201, v137
    v_add_f32 v240, v240, v199
    v_cvt_pk_bf16_f32 v224, v192, v193
    v_mfma_f32_32x32x16_bf16 v[144:159], a[168:171], v[104:107], v[144:159]
    v_exp_f32 v202, v138
    v_exp_f32 v203, v139
    v_add_f32 v240, v240, v200
    v_mfma_f32_32x32x16_bf16 v[144:159], a[172:175], v[108:111], v[144:159]
    v_exp_f32 v204, v140
    v_add_f32 v240, v240, v201
    v_cvt_pk_bf16_f32 v225, v194, v195
    v_add_f32 v240, v240, v202
    v_mfma_f32_32x32x16_bf16 v[144:159], a[176:179], v[112:115], v[144:159]
    v_exp_f32 v205, v141
    v_add_f32 v240, v240, v203
    v_cvt_pk_bf16_f32 v226, v196, v197
    v_mfma_f32_32x32x16_bf16 v[144:159], a[180:183], v[116:119], v[144:159]
    v_exp_f32 v206, v142
    v_add_f32 v240, v240, v204
    v_cvt_pk_bf16_f32 v227, v198, v199
    v_add_f32 v240, v240, v205
    v_mfma_f32_32x32x16_bf16 v[144:159], a[184:187], v[120:123], v[144:159]
    v_exp_f32 v207, v143
    v_add_f32 v240, v240, v206
    v_add_f32 v240, v240, v207
    v_cmp_lt_f32 vcc, s6, v240
    v_mfma_f32_32x32x16_bf16 v[144:159], a[188:191], v[124:127], v[144:159]
    s_cbranch_vccnz L_stub_1
L_ret_1:
    s_nop 0
    s_add_u32 s7, s12, 0x0
    v_mfma_f32_32x32x16_bf16 a[0:15], a[224:227], v[224:227], a[0:15]
    buffer_load_dwordx4 a[160:163], v4, s[92:95], s7 offen offset:0 sc1
    v_cvt_pk_bf16_f32 v228, v200, v201
    v_cvt_pk_bf16_f32 v229, v202, v203
    v_mfma_f32_32x32x16_bf16 a[16:31], a[228:231], v[224:227], a[16:31]
    buffer_load_dwordx4 a[164:167], v4, s[92:95], s7 offen offset:1024 sc1
    v_cvt_pk_bf16_f32 v230, v204, v205
    v_cvt_pk_bf16_f32 v231, v206, v207
    v_add_f32 v242, v242, v240
    v_mfma_f32_32x32x16_bf16 a[32:47], a[232:235], v[224:227], a[32:47]
    buffer_load_dwordx4 a[168:171], v4, s[92:95], s7 offen offset:2048 sc1
    v_exp_f32 v192, v144
    v_exp_f32 v193, v145
    v_mfma_f32_32x32x16_bf16 a[48:63], a[236:239], v[224:227], a[48:63]
    buffer_load_dwordx4 a[172:175], v4, s[92:95], s7 offen offset:3072 sc1
    v_exp_f32 v194, v146
    v_add_f32 v241, v192, v193
    v_mfma_f32_32x32x16_bf16 a[0:15], a[240:243], v[228:231], a[0:15]
    buffer_load_dwordx4 a[176:179], v5, s[92:95], s7 offen offset:0 sc1
    v_exp_f32 v195, v147
    v_add_f32 v241, v241, v194
    v_mfma_f32_32x32x16_bf16 a[16:31], a[244:247], v[228:231], a[16:31]
    buffer_load_dwordx4 a[180:183], v5, s[92:95], s7 offen offset:1024 sc1
    v_exp_f32 v196, v148
    v_add_f32 v241, v241, v195
    v_mfma_f32_32x32x16_bf16 a[32:47], a[248:251], v[228:231], a[32:47]
    buffer_load_dwordx4 a[184:187], v5, s[92:95], s7 offen offset:2048 sc1
    v_exp_f32 v197, v149
    v_add_f32 v241, v241, v196
    v_mfma_f32_32x32x16_bf16 a[48:63], a[252:255], v[228:231], a[48:63]
    buffer_load_dwordx4 a[188:191], v5, s[92:95], s7 offen offset:3072 sc1
    v_exp_f32 v198, v150
    v_add_f32 v241, v241, v197
    buffer_load_dwordx2 v[54:55], v51, s[92:95], 0 offen offset:1024 sc1
    s_waitcnt vmcnt(24)
    v_mfma_f32_32x32x16_bf16 v[128:143], a[128:131], v[64:67], v[160:175]
    v_exp_f32 v199, v151
    v_exp_f32 v200, v152
    v_add_f32 v241, v241, v198
    v_mfma_f32_32x32x16_bf16 v[128:143], a[132:135], v[68:71], v[128:143]
    v_exp_f32 v201, v153
    v_add_f32 v241, v241, v199
    v_cvt_pk_bf16_f32 v232, v192, v193
    v_mfma_f32_32x32x16_bf16 v[128:143], a[136:139], v[72:75], v[128:143]
    v_exp_f32 v202, v154
    v_exp_f32 v203, v155
    v_add_f32 v241, v241, v200
    v_mfma_f32_32x32x16_bf16 v[128:143], a[140:143], v[76:79], v[128:143]
    v_exp_f32 v204, v156
    v_add_f32 v241, v241, v201
    v_cvt_pk_bf16_f32 v233, v194, v195
    v_add_f32 v241, v241, v202
    s_waitcnt vmcnt(20)
    v_mfma_f32_32x32x16_bf16 v[128:143], a[144:147], v[80:83], v[128:143]
    v_exp_f32 v205, v157
    v_add_f32 v241, v241, v203
    v_cvt_pk_bf16_f32 v234, v196, v197
    v_mfma_f32_32x32x16_bf16 v[128:143], a[148:151], v[84:87], v[128:143]
    v_exp_f32 v206, v158
    v_add_f32 v241, v241, v204
    v_cvt_pk_bf16_f32 v235, v198, v199
    v_add_f32 v241, v241, v205
    v_mfma_f32_32x32x16_bf16 v[128:143], a[152:155], v[88:91], v[128:143]
    v_exp_f32 v207, v159
    v_add_f32 v241, v241, v206
    v_add_f32 v241, v241, v207
    v_cmp_lt_f32 vcc, s6, v241
    v_mfma_f32_32x32x16_bf16 v[128:143], a[156:159], v[92:95], v[128:143]
    s_cbranch_vccnz L_stub_2
L_ret_2:
    s_nop 0
    s_add_u32 s8, s12, 0x0
    v_mfma_f32_32x32x16_bf16 a[64:79], a[224:227], v[232:235], a[64:79]
    buffer_load_dwordx4 a[224:227], v6, s[92:95], s8 offen offset:0 sc1
    v_cvt_pk_bf16_f32 v236, v200, v201
    v_cvt_pk_bf16_f32 v237, v202, v203
    v_mfma_f32_32x32x16_bf16 a[80:95], a[228:231], v[232:235], a[80:95]
    buffer_load_dwordx4 a[228:231], v6, s[92:95], s8 offen offset:1024 sc1
    v_cvt_pk_bf16_f32 v238, v204, v205
    v_cvt_pk_bf16_f32 v239, v206, v207
    v_add_f32 v243, v243, v241
    v_mfma_f32_32x32x16_bf16 a[96:111], a[232:235], v[232:235], a[96:111]
    buffer_load_dwordx4 a[232:235], v6, s[92:95], s8 offen offset:2048 sc1
    v_exp_f32 v192, v128
    v_exp_f32 v193, v129
    v_mfma_f32_32x32x16_bf16 a[112:127], a[236:239], v[232:235], a[112:127]
    buffer_load_dwordx4 a[236:239], v6, s[92:95], s8 offen offset:3072 sc1
    v_exp_f32 v194, v130
    v_add_f32 v240, v192, v193
    v_mfma_f32_32x32x16_bf16 a[64:79], a[240:243], v[236:239], a[64:79]
    buffer_load_dwordx4 a[240:243], v7, s[92:95], s8 offen offset:0 sc1
    v_exp_f32 v195, v131
    v_add_f32 v240, v240, v194
    v_mfma_f32_32x32x16_bf16 a[80:95], a[244:247], v[236:239], a[80:95]
    buffer_load_dwordx4 a[244:247], v7, s[92:95], s8 offen offset:1024 sc1
    v_exp_f32 v196, v132
    v_add_f32 v240, v240, v195
    v_mfma_f32_32x32x16_bf16 a[96:111], a[248:251], v[236:239], a[96:111]
    buffer_load_dwordx4 a[248:251], v7, s[92:95], s8 offen offset:2048 sc1
    v_exp_f32 v197, v133
    v_add_f32 v240, v240, v196
    v_mfma_f32_32x32x16_bf16 a[112:127], a[252:255], v[236:239], a[112:127]
    buffer_load_dwordx4 a[252:255], v7, s[92:95], s8 offen offset:3072 sc1
    v_exp_f32 v198, v134
    v_add_f32 v240, v240, v197
    s_waitcnt vmcnt(26)
    s_lshl_b32 s14, s21, 1
    s_mov_b64 exec, 1
    buffer_store_dwordx2 v[52:53], v50, s[92:95], s14 offen offset:3072 sc1
    s_mov_b64 exec, -1
    v_mfma_f32_32x32x16_bf16 v[144:159], a[128:131], v[96:99], v[176:191]
    v_exp_f32 v199, v135
    v_exp_f32 v200, v136
    v_add_f32 v240, v240, v198
    v_mfma_f32_32x32x16_bf16 v[144:159], a[132:135], v[100:103], v[144:159]
    v_exp_f32 v201, v137
    v_add_f32 v240, v240, v199
    v_cvt_pk_bf16_f32 v224, v192, v193
    v_mfma_f32_32x32x16_bf16 v[144:159], a[136:139], v[104:107], v[144:159]
    v_exp_f32 v202, v138
    v_exp_f32 v203, v139
    v_add_f32 v240, v240, v200
    v_mfma_f32_32x32x16_bf16 v[144:159], a[140:143], v[108:111], v[144:159]
    v_exp_f32 v204, v140
    v_add_f32 v240, v240, v201
    v_cvt_pk_bf16_f32 v225, v194, v195
    v_add_f32 v240, v240, v202
    v_mfma_f32_32x32x16_bf16 v[144:159], a[144:147], v[112:115], v[144:159]
    v_exp_f32 v205, v141
    v_add_f32 v240, v240, v203
    v_cvt_pk_bf16_f32 v226, v196, v197
    v_mfma_f32_32x32x16_bf16 v[144:159], a[148:151], v[116:119], v[144:159]
    v_exp_f32 v206, v142
    v_add_f32 v240, v240, v204
    v_cvt_pk_bf16_f32 v227, v198, v199
    v_add_f32 v240, v240, v205
    v_mfma_f32_32x32x16_bf16 v[144:159], a[152:155], v[120:123], v[144:159]
    v_exp_f32 v207, v143
    v_add_f32 v240, v240, v206
    v_add_f32 v240, v240, v207
    v_cmp_lt_f32 vcc, s6, v240
    v_mfma_f32_32x32x16_bf16 v[144:159], a[156:159], v[124:127], v[144:159]
    s_cbranch_vccnz L_stub_3
L_ret_3:
    s_nop 0
    s_waitcnt vmcnt(9)
    v_cmp_ne_u64 vcc, s[96:97], v[54:55]
    s_cbranch_vccnz L_spin_1
L_spinret_1:
    s_add_u32 s7, s9, 0x40000
    v_mfma_f32_32x32x16_bf16 a[0:15], a[192:195], v[224:227], a[0:15]
    buffer_load_dwordx4 a[128:131], v4, s[92:95], s7 offen offset:0 sc1
    v_cvt_pk_bf16_f32 v228, v200, v201
    v_cvt_pk_bf16_f32 v229, v202, v203
    v_mfma_f32_32x32x16_bf16 a[16:31], a[196:199], v[224:227], a[16:31]
    buffer_load_dwordx4 a[132:135], v4, s[92:95], s7 offen offset:1024 sc1
    v_cvt_pk_bf16_f32 v230, v204, v205
    v_cvt_pk_bf16_f32 v231, v206, v207
    v_add_f32 v242, v242, v240
    v_mfma_f32_32x32x16_bf16 a[32:47], a[200:203], v[224:227], a[32:47]
    buffer_load_dwordx4 a[136:139], v4, s[92:95], s7 offen offset:2048 sc1
    v_exp_f32 v192, v144
    v_exp_f32 v193, v145
    v_mfma_f32_32x32x16_bf16 a[48:63], a[204:207], v[224:227], a[48:63]
    buffer_load_dwordx4 a[140:143], v4, s[92:95], s7 offen offset:3072 sc1
    v_exp_f32 v194, v146
    v_add_f32 v241, v192, v193
    v_mfma_f32_32x32x16_bf16 a[0:15], a[208:211], v[228:231], a[0:15]
    buffer_load_dwordx4 a[144:147], v5, s[92:95], s7 offen offset:0 sc1
    v_exp_f32 v195, v147
    v_add_f32 v241, v241, v194
    v_mfma_f32_32x32x16_bf16 a[16:31], a[212:215], v[228:231], a[16:31]
    buffer_load_dwordx4 a[148:151], v5, s[92:95], s7 offen offset:1024 sc1
    v_exp_f32 v196, v148
    v_add_f32 v241, v241, v195
    v_mfma_f32_32x32x16_bf16 a[32:47], a[216:219], v[228:231], a[32:47]
    buffer_load_dwordx4 a[152:155], v5, s[92:95], s7 offen offset:2048 sc1
    v_exp_f32 v197, v149
    v_add_f32 v241, v241, v196
    v_mfma_f32_32x32x16_bf16 a[48:63], a[220:223], v[228:231], a[48:63]
    buffer_load_dwordx4 a[156:159], v5, s[92:95], s7 offen offset:3072 sc1
    v_exp_f32 v198, v150
    v_add_f32 v241, v241, v197
    v_mfma_f32_32x32x16_bf16 v[128:143], a[160:163], v[64:67], v[160:175]
    v_exp_f32 v199, v151
    v_exp_f32 v200, v152
    v_add_f32 v241, v241, v198
    v_mfma_f32_32x32x16_bf16 v[128:143], a[164:167], v[68:71], v[128:143]
    v_exp_f32 v201, v153
    v_add_f32 v241, v241, v199
    v_cvt_pk_bf16_f32 v232, v192, v193
    v_mfma_f32_32x32x16_bf16 v[128:143], a[168:171], v[72:75], v[128:143]
    v_exp_f32 v202, v154
    v_exp_f32 v203, v155
    v_add_f32 v241, v241, v200
    v_mfma_f32_32x32x16_bf16 v[128:143], a[172:175], v[76:79], v[128:143]
    v_exp_f32 v204, v156
    v_add_f32 v241, v241, v201
    v_cvt_pk_bf16_f32 v233, v194, v195
    v_add_f32 v241, v241, v202
    v_mfma_f32_32x32x16_bf16 v[128:143], a[176:179], v[80:83], v[128:143]
    v_exp_f32 v205, v157
    v_add_f32 v241, v241, v203
    v_cvt_pk_bf16_f32 v234, v196, v197
    v_mfma_f32_32x32x16_bf16 v[128:143], a[180:183], v[84:87], v[128:143]
    v_exp_f32 v206, v158
    v_add_f32 v241, v241, v204
    v_cvt_pk_bf16_f32 v235, v198, v199
    v_add_f32 v241, v241, v205
    v_mfma_f32_32x32x16_bf16 v[128:143], a[184:187], v[88:91], v[128:143]
    v_exp_f32 v207, v159
    v_add_f32 v241, v241, v206
    v_add_f32 v241, v241, v207
    v_cmp_lt_f32 vcc, s6, v241
    v_mfma_f32_32x32x16_bf16 v[128:143], a[188:191], v[92:95], v[128:143]
    s_cbranch_vccnz L_stub_4
L_ret_4:
    s_nop 0
    s_add_u32 s8, s9, 0x40000
    v_mfma_f32_32x32x16_bf16 a[64:79], a[192:195], v[232:235], a[64:79]
    buffer_load_dwordx4 a[192:195], v6, s[92:95], s8 offen offset:0 sc1
    v_cvt_pk_bf16_f32 v236, v200, v201
    v_cvt_pk_bf16_f32 v237, v202, v203
    v_mfma_f32_32x32x16_bf16 a[80:95], a[196:199], v[232:235], a[80:95]
    buffer_load_dwordx4 a[196:199], v6, s[92:95], s8 offen offset:1024 sc1
    v_cvt_pk_bf16_f32 v238, v204, v205
    v_cvt_pk_bf16_f32 v239, v206, v207
    v_add_f32 v243, v243, v241
    v_mfma_f32_32x32x16_bf16 a[96:111], a[200:203], v[232:235], a[96:111]
    buffer_load_dwordx4 a[200:203], v6, s[92:95], s8 offen offset:2048 sc1
    v_exp_f32 v192, v128
    v_exp_f32 v193, v129
    v_mfma_f32_32x32x16_bf16 a[112:127], a[204:207], v[232:235], a[112:127]
    buffer_load_dwordx4 a[204:207], v6, s[92:95], s8 offen offset:3072 sc1
    v_exp_f32 v194, v130
    v_add_f32 v240, v192, v193
    v_mfma_f32_32x32x16_bf16 a[64:79], a[208:211], v[236:239], a[64:79]
    buffer_load_dwordx4 a[208:211], v7, s[92:95], s8 offen offset:0 sc1
    v_exp_f32 v195, v131
    v_add_f32 v240, v240, v194
    v_mfma_f32_32x32x16_bf16 a[80:95], a[212:215], v[236:239], a[80:95]
    buffer_load_dwordx4 a[212:215], v7, s[92:95], s8 offen offset:1024 sc1
    v_exp_f32 v196, v132
    v_add_f32 v240, v240, v195
    v_mfma_f32_32x32x16_bf16 a[96:111], a[216:219], v[236:239], a[96:111]
    buffer_load_dwordx4 a[216:219], v7, s[92:95], s8 offen offset:2048 sc1
    v_exp_f32 v197, v133
    v_add_f32 v240, v240, v196
    v_mfma_f32_32x32x16_bf16 a[112:127], a[220:223], v[236:239], a[112:127]
    buffer_load_dwordx4 a[220:223], v7, s[92:95], s8 offen offset:3072 sc1
    v_exp_f32 v198, v134
    v_add_f32 v240, v240, v197
    v_mfma_f32_32x32x16_bf16 v[144:159], a[160:163], v[96:99], v[176:191]
    v_exp_f32 v199, v135
    v_exp_f32 v200, v136
    v_add_f32 v240, v240, v198
    v_mfma_f32_32x32x16_bf16 v[144:159], a[164:167], v[100:103], v[144:159]
    v_exp_f32 v201, v137
    v_add_f32 v240, v240, v199
    v_cvt_pk_bf16_f32 v224, v192, v193
    v_mfma_f32_32x32x16_bf16 v[144:159], a[168:171], v[104:107], v[144:159]
    v_exp_f32 v202, v138
    v_exp_f32 v203, v139
    v_add_f32 v240, v240, v200
    v_mfma_f32_32x32x16_bf16 v[144:159], a[172:175], v[108:111], v[144:159]
    v_exp_f32 v204, v140
    v_add_f32 v240, v240, v201
    v_cvt_pk_bf16_f32 v225, v194, v195
    v_add_f32 v240, v240, v202
    v_mfma_f32_32x32x16_bf16 v[144:159], a[176:179], v[112:115], v[144:159]
    v_exp_f32 v205, v141
    v_add_f32 v240, v240, v203
    v_cvt_pk_bf16_f32 v226, v196, v197
    v_mfma_f32_32x32x16_bf16 v[144:159], a[180:183], v[116:119], v[144:159]
    v_exp_f32 v206, v142
    v_add_f32 v240, v240, v204
    v_cvt_pk_bf16_f32 v227, v198, v199
    v_add_f32 v240, v240, v205
    v_mfma_f32_32x32x16_bf16 v[144:159], a[184:187], v[120:123], v[144:159]
    v_exp_f32 v207, v143
    v_add_f32 v240, v240, v206
    v_add_f32 v240, v240, v207
    v_cmp_lt_f32 vcc, s6, v240
    v_mfma_f32_32x32x16_bf16 v[144:159], a[188:191], v[124:127], v[144:159]
    s_cbranch_vccnz L_stub_5
L_ret_5:
    s_nop 0
    s_waitcnt vmcnt(17)
    s_add_u32 s7, s10, 0x40000
    v_mfma_f32_32x32x16_bf16 a[0:15], a[224:227], v[224:227], a[0:15]
    buffer_load_dwordx4 a[160:163], v4, s[92:95], s7 offen offset:0 sc1
    v_cvt_pk_bf16_f32 v228, v200, v201
    v_cvt_pk_bf16_f32 v229, v202, v203
    v_mfma_f32_32x32x16_bf16 a[16:31], a[228:231], v[224:227], a[16:31]
    buffer_load_dwordx4 a[164:167], v4, s[92:95], s7 offen offset:1024 sc1
    v_cvt_pk_bf16_f32 v230, v204, v205
    v_cvt_pk_bf16_f32 v231, v206, v207
    v_add_f32 v242, v242, v240
    v_mfma_f32_32x32x16_bf16 a[32:47], a[232:235], v[224:227], a[32:47]
    buffer_load_dwordx4 a[168:171], v4, s[92:95], s7 offen offset:2048 sc1
    v_exp_f32 v192, v144
    v_exp_f32 v193, v145
    v_mfma_f32_32x32x16_bf16 a[48:63], a[236:239], v[224:227], a[48:63]
    buffer_load_dwordx4 a[172:175], v4, s[92:95], s7 offen offset:3072 sc1
    v_exp_f32 v194, v146
    v_add_f32 v241, v192, v193
    v_mfma_f32_32x32x16_bf16 a[0:15], a[240:243], v[228:231], a[0:15]
    buffer_load_dwordx4 a[176:179], v5, s[92:95], s7 offen offset:0 sc1
    v_exp_f32 v195, v147
    v_add_f32 v241, v241, v194
    v_mfma_f32_32x32x16_bf16 a[16:31], a[244:247], v[228:231], a[16:31]
    buffer_load_dwordx4 a[180:183], v5, s[92:95], s7 offen offset:1024 sc1
    v_exp_f32 v196, v148
    v_add_f32 v241, v241, v195
    v_mfma_f32_32x32x16_bf16 a[32:47], a[248:251], v[228:231], a[32:47]
    buffer_load_dwordx4 a[184:187], v5, s[92:95], s7 offen offset:2048 sc1
    v_exp_f32 v197, v149
    v_add_f32 v241, v241, v196
    v_mfma_f32_32x32x16_bf16 a[48:63], a[252:255], v[228:231], a[48:63]
    buffer_load_dwordx4 a[188:191], v5, s[92:95], s7 offen offset:3072 sc1
    v_exp_f32 v198, v150
    v_add_f32 v241, v241, v197
    s_waitcnt vmcnt(20)
    v_mfma_f32_32x32x16_bf16 v[128:143], a[128:131], v[64:67], v[160:175]
    v_exp_f32 v199, v151
    v_exp_f32 v200, v152
    v_add_f32 v241, v241, v198
    v_mfma_f32_32x32x16_bf16 v[128:143], a[132:135], v[68:71], v[128:143]
    v_exp_f32 v201, v153
    v_add_f32 v241, v241, v199
    v_cvt_pk_bf16_f32 v232, v192, v193
    v_mfma_f32_32x32x16_bf16 v[128:143], a[136:139], v[72:75], v[128:143]
    v_exp_f32 v202, v154
    v_exp_f32 v203, v155
    v_add_f32 v241, v241, v200
    v_mfma_f32_32x32x16_bf16 v[128:143], a[140:143], v[76:79], v[128:143]
    v_exp_f32 v204, v156
    v_add_f32 v241, v241, v201
    v_cvt_pk_bf16_f32 v233, v194, v195
    v_add_f32 v241, v241, v202
    s_waitcnt vmcnt(16)
    v_mfma_f32_32x32x16_bf16 v[128:143], a[144:147], v[80:83], v[128:143]
    v_exp_f32 v205, v157
    v_add_f32 v241, v241, v203
    v_cvt_pk_bf16_f32 v234, v196, v197
    v_mfma_f32_32x32x16_bf16 v[128:143], a[148:151], v[84:87], v[128:143]
    v_exp_f32 v206, v158
    v_add_f32 v241, v241, v204
    v_cvt_pk_bf16_f32 v235, v198, v199
    v_add_f32 v241, v241, v205
    v_mfma_f32_32x32x16_bf16 v[128:143], a[152:155], v[88:91], v[128:143]
    v_exp_f32 v207, v159
    v_add_f32 v241, v241, v206
    v_add_f32 v241, v241, v207
    v_cmp_lt_f32 vcc, s6, v241
    v_mfma_f32_32x32x16_bf16 v[128:143], a[156:159], v[92:95], v[128:143]
    s_cbranch_vccnz L_stub_6
L_ret_6:
    s_nop 0
    s_add_u32 s8, s10, 0x40000
    v_mfma_f32_32x32x16_bf16 a[64:79], a[224:227], v[232:235], a[64:79]
    buffer_load_dwordx4 a[224:227], v6, s[92:95], s8 offen offset:0 sc1
    v_cvt_pk_bf16_f32 v236, v200, v201
    v_cvt_pk_bf16_f32 v237, v202, v203
    v_mfma_f32_32x32x16_bf16 a[80:95], a[228:231], v[232:235], a[80:95]
    buffer_load_dwordx4 a[228:231], v6, s[92:95], s8 offen offset:1024 sc1
    v_cvt_pk_bf16_f32 v238, v204, v205
    v_cvt_pk_bf16_f32 v239, v206, v207
    v_add_f32 v243, v243, v241
    v_mfma_f32_32x32x16_bf16 a[96:111], a[232:235], v[232:235], a[96:111]
    buffer_load_dwordx4 a[232:235], v6, s[92:95], s8 offen offset:2048 sc1
    v_exp_f32 v192, v128
    v_exp_f32 v193, v129
    v_mfma_f32_32x32x16_bf16 a[112:127], a[236:239], v[232:235], a[112:127]
    buffer_load_dwordx4 a[236:239], v6, s[92:95], s8 offen offset:3072 sc1
    v_exp_f32 v194, v130
    v_add_f32 v240, v192, v193
    v_mfma_f32_32x32x16_bf16 a[64:79], a[240:243], v[236:239], a[64:79]
    buffer_load_dwordx4 a[240:243], v7, s[92:95], s8 offen offset:0 sc1
    v_exp_f32 v195, v131
    v_add_f32 v240, v240, v194
    v_mfma_f32_32x32x16_bf16 a[80:95], a[244:247], v[236:239], a[80:95]
    buffer_load_dwordx4 a[244:247], v7, s[92:95], s8 offen offset:1024 sc1
    v_exp_f32 v196, v132
    v_add_f32 v240, v240, v195
    v_mfma_f32_32x32x16_bf16 a[96:111], a[248:251], v[236:239], a[96:111]
    buffer_load_dwordx4 a[248:251], v7, s[92:95], s8 offen offset:2048 sc1
    v_exp_f32 v197, v133
    v_add_f32 v240, v240, v196
    v_mfma_f32_32x32x16_bf16 a[112:127], a[252:255], v[236:239], a[112:127]
    buffer_load_dwordx4 a[252:255], v7, s[92:95], s8 offen offset:3072 sc1
    v_exp_f32 v198, v134
    v_add_f32 v240, v240, v197
    v_mfma_f32_32x32x16_bf16 v[144:159], a[128:131], v[96:99], v[176:191]
    v_exp_f32 v199, v135
    v_exp_f32 v200, v136
    v_add_f32 v240, v240, v198
    v_mfma_f32_32x32x16_bf16 v[144:159], a[132:135], v[100:103], v[144:159]
    v_exp_f32 v201, v137
    v_add_f32 v240, v240, v199
    v_cvt_pk_bf16_f32 v224, v192, v193
    v_mfma_f32_32x32x16_bf16 v[144:159], a[136:139], v[104:107], v[144:159]
    v_exp_f32 v202, v138
    v_exp_f32 v203, v139
    v_add_f32 v240, v240, v200
    v_mfma_f32_32x32x16_bf16 v[144:159], a[140:143], v[108:111], v[144:159]
    v_exp_f32 v204, v140
    v_add_f32 v240, v240, v201
    v_cvt_pk_bf16_f32 v225, v194, v195
    v_add_f32 v240, v240, v202
    v_mfma_f32_32x32x16_bf16 v[144:159], a[144:147], v[112:115], v[144:159]
    v_exp_f32 v205, v141
    v_add_f32 v240, v240, v203
    v_cvt_pk_bf16_f32 v226, v196, v197
    v_mfma_f32_32x32x16_bf16 v[144:159], a[148:151], v[116:119], v[144:159]
    v_exp_f32 v206, v142
    v_add_f32 v240, v240, v204
    v_cvt_pk_bf16_f32 v227, v198, v199
    v_add_f32 v240, v240, v205
    v_mfma_f32_32x32x16_bf16 v[144:159], a[152:155], v[120:123], v[144:159]
    v_exp_f32 v207, v143
    v_add_f32 v240, v240, v206
    v_add_f32 v240, v240, v207
    v_cmp_lt_f32 vcc, s6, v240
    v_mfma_f32_32x32x16_bf16 v[144:159], a[156:159], v[124:127], v[144:159]
    s_cbranch_vccnz L_stub_7
L_ret_7:
    s_nop 0
    s_waitcnt vmcnt(16)
    s_add_u32 s7, s11, 0x40000
    v_mfma_f32_32x32x16_bf16 a[0:15], a[192:195], v[224:227], a[0:15]
    buffer_load_dwordx4 a[128:131], v4, s[92:95], s7 offen offset:0 sc1
    v_cvt_pk_bf16_f32 v228, v200, v201
    v_cvt_pk_bf16_f32 v229, v202, v203
    v_mfma_f32_32x32x16_bf16 a[16:31], a[196:199], v[224:227], a[16:31]
    buffer_load_dwordx4 a[132:135], v4, s[92:95], s7 offen offset:1024 sc1
    v_cvt_pk_bf16_f32 v230, v204, v205
    v_cvt_pk_bf16_f32 v231, v206, v207
    v_add_f32 v242, v242, v240
    v_mfma_f32_32x32x16_bf16 a[32:47], a[200:203], v[224:227], a[32:47]
    buffer_load_dwordx4 a[136:139], v4, s[92:95], s7 offen offset:2048 sc1
    v_exp_f32 v192, v144
    v_exp_f32 v193, v145
    v_mfma_f32_32x32x16_bf16 a[48:63], a[204:207], v[224:227], a[48:63]
    buffer_load_dwordx4 a[140:143], v4, s[92:95], s7 offen offset:3072 sc1
    v_exp_f32 v194, v146
    v_add_f32 v241, v192, v193
    v_mfma_f32_32x32x16_bf16 a[0:15], a[208:211], v[228:231], a[0:15]
    buffer_load_dwordx4 a[144:147], v5, s[92:95], s7 offen offset:0 sc1
    v_exp_f32 v195, v147
    v_add_f32 v241, v241, v194
    v_mfma_f32_32x32x16_bf16 a[16:31], a[212:215], v[228:231], a[16:31]
    buffer_load_dwordx4 a[148:151], v5, s[92:95], s7 offen offset:1024 sc1
    v_exp_f32 v196, v148
    v_add_f32 v241, v241, v195
    v_mfma_f32_32x32x16_bf16 a[32:47], a[216:219], v[228:231], a[32:47]
    buffer_load_dwordx4 a[152:155], v5, s[92:95], s7 offen offset:2048 sc1
    v_exp_f32 v197, v149
    v_add_f32 v241, v241, v196
    v_mfma_f32_32x32x16_bf16 a[48:63], a[220:223], v[228:231], a[48:63]
    buffer_load_dwordx4 a[156:159], v5, s[92:95], s7 offen offset:3072 sc1
    v_exp_f32 v198, v150
    v_add_f32 v241, v241, v197
    s_waitcnt vmcnt(20)
    v_mfma_f32_32x32x16_bf16 v[128:143], a[160:163], v[64:67], v[160:175]
    v_exp_f32 v199, v151
    v_exp_f32 v200, v152
    v_add_f32 v241, v241, v198
    v_mfma_f32_32x32x16_bf16 v[128:143], a[164:167], v[68:71], v[128:143]
    v_exp_f32 v201, v153
    v_add_f32 v241, v241, v199
    v_cvt_pk_bf16_f32 v232, v192, v193
    v_mfma_f32_32x32x16_bf16 v[128:143], a[168:171], v[72:75], v[128:143]
    v_exp_f32 v202, v154
    v_exp_f32 v203, v155
    v_add_f32 v241, v241, v200
    v_mfma_f32_32x32x16_bf16 v[128:143], a[172:175], v[76:79], v[128:143]
    v_exp_f32 v204, v156
    v_add_f32 v241, v241, v201
    v_cvt_pk_bf16_f32 v233, v194, v195
    v_add_f32 v241, v241, v202
    s_waitcnt vmcnt(16)
    v_mfma_f32_32x32x16_bf16 v[128:143], a[176:179], v[80:83], v[128:143]
    v_exp_f32 v205, v157
    v_add_f32 v241, v241, v203
    v_cvt_pk_bf16_f32 v234, v196, v197
    v_mfma_f32_32x32x16_bf16 v[128:143], a[180:183], v[84:87], v[128:143]
    v_exp_f32 v206, v158
    v_add_f32 v241, v241, v204
    v_cvt_pk_bf16_f32 v235, v198, v199
    v_add_f32 v241, v241, v205
    v_mfma_f32_32x32x16_bf16 v[128:143], a[184:187], v[88:91], v[128:143]
    v_exp_f32 v207, v159
    v_add_f32 v241, v241, v206
    v_add_f32 v241, v241, v207
    v_cmp_lt_f32 vcc, s6, v241
    v_mfma_f32_32x32x16_bf16 v[128:143], a[188:191], v[92:95], v[128:143]
    s_cbranch_vccnz L_stub_8
L_ret_8:
    s_nop 0
    s_add_u32 s8, s11, 0x40000
    v_mfma_f32_32x32x16_bf16 a[64:79], a[192:195], v[232:235], a[64:79]
    buffer_load_dwordx4 a[192:195], v6, s[92:95], s8 offen offset:0 sc1
    v_cvt_pk_bf16_f32 v236, v200, v201
    v_cvt_pk_bf16_f32 v237, v202, v203
    v_mfma_f32_32x32x16_bf16 a[80:95], a[196:199], v[232:235], a[80:95]
    buffer_load_dwordx4 a[196:199], v6, s[92:95], s8 offen offset:1024 sc1
    v_cvt_pk_bf16_f32 v238, v204, v205
    v_cvt_pk_bf16_f32 v239, v206, v207
    v_add_f32 v243, v243, v241
    v_mfma_f32_32x32x16_bf16 a[96:111], a[200:203], v[232:235], a[96:111]
    buffer_load_dwordx4 a[200:203], v6, s[92:95], s8 offen offset:2048 sc1
    v_exp_f32 v192, v128
    v_exp_f32 v193, v129
    v_mfma_f32_32x32x16_bf16 a[112:127], a[204:207], v[232:235], a[112:127]
    buffer_load_dwordx4 a[204:207], v6, s[92:95], s8 offen offset:3072 sc1
    v_exp_f32 v194, v130
    v_add_f32 v240, v192, v193
    v_mfma_f32_32x32x16_bf16 a[64:79], a[208:211], v[236:239], a[64:79]
    buffer_load_dwordx4 a[208:211], v7, s[92:95], s8 offen offset:0 sc1
    v_exp_f32 v195, v131
    v_add_f32 v240, v240, v194
    v_mfma_f32_32x32x16_bf16 a[80:95], a[212:215], v[236:239], a[80:95]
    buffer_load_dwordx4 a[212:215], v7, s[92:95], s8 offen offset:1024 sc1
    v_exp_f32 v196, v132
    v_add_f32 v240, v240, v195
    v_mfma_f32_32x32x16_bf16 a[96:111], a[216:219], v[236:239], a[96:111]
    buffer_load_dwordx4 a[216:219], v7, s[92:95], s8 offen offset:2048 sc1
    v_exp_f32 v197, v133
    v_add_f32 v240, v240, v196
    v_mfma_f32_32x32x16_bf16 a[112:127], a[220:223], v[236:239], a[112:127]
    buffer_load_dwordx4 a[220:223], v7, s[92:95], s8 offen offset:3072 sc1
    v_exp_f32 v198, v134
    v_add_f32 v240, v240, v197
    v_mfma_f32_32x32x16_bf16 v[144:159], a[160:163], v[96:99], v[176:191]
    v_exp_f32 v199, v135
    v_exp_f32 v200, v136
    v_add_f32 v240, v240, v198
    v_mfma_f32_32x32x16_bf16 v[144:159], a[164:167], v[100:103], v[144:159]
    v_exp_f32 v201, v137
    v_add_f32 v240, v240, v199
    v_cvt_pk_bf16_f32 v224, v192, v193
    v_mfma_f32_32x32x16_bf16 v[144:159], a[168:171], v[104:107], v[144:159]
    v_exp_f32 v202, v138
    v_exp_f32 v203, v139
    v_add_f32 v240, v240, v200
    v_mfma_f32_32x32x16_bf16 v[144:159], a[172:175], v[108:111], v[144:159]
    v_exp_f32 v204, v140
    v_add_f32 v240, v240, v201
    v_cvt_pk_bf16_f32 v225, v194, v195
    v_add_f32 v240, v240, v202
    v_mfma_f32_32x32x16_bf16 v[144:159], a[176:179], v[112:115], v[144:159]
    v_exp_f32 v205, v141
    v_add_f32 v240, v240, v203
    v_cvt_pk_bf16_f32 v226, v196, v197
    v_mfma_f32_32x32x16_bf16 v[144:159], a[180:183], v[116:119], v[144:159]
    v_exp_f32 v206, v142
    v_add_f32 v240, v240, v204
    v_cvt_pk_bf16_f32 v227, v198, v199
    v_add_f32 v240, v240, v205
    v_mfma_f32_32x32x16_bf16 v[144:159], a[184:187], v[120:123], v[144:159]
    v_exp_f32 v207, v143
    v_add_f32 v240, v240, v206
    v_add_f32 v240, v240, v207
    v_cmp_lt_f32 vcc, s6, v240
    v_mfma_f32_32x32x16_bf16 v[144:159], a[188:191], v[124:127], v[144:159]
    s_cbranch_vccnz L_stub_9
L_ret_9:
    s_nop 0
    s_waitcnt vmcnt(16)
    s_add_u32 s7, s12, 0x40000
    v_mfma_f32_32x32x16_bf16 a[0:15], a[224:227], v[224:227], a[0:15]
    buffer_load_dwordx4 a[160:163], v4, s[92:95], s7 offen offset:0 sc1
    v_cvt_pk_bf16_f32 v228, v200, v201
    v_cvt_pk_bf16_f32 v229, v202, v203
    v_mfma_f32_32x32x16_bf16 a[16:31], a[228:231], v[224:227], a[16:31]
    buffer_load_dwordx4 a[164:167], v4, s[92:95], s7 offen offset:1024 sc1
    v_cvt_pk_bf16_f32 v230, v204, v205
    v_cvt_pk_bf16_f32 v231, v206, v207
    v_add_f32 v242, v242, v240
    v_mfma_f32_32x32x16_bf16 a[32:47], a[232:235], v[224:227], a[32:47]
    buffer_load_dwordx4 a[168:171], v4, s[92:95], s7 offen offset:2048 sc1
    v_exp_f32 v192, v144
    v_exp_f32 v193, v145
    v_mfma_f32_32x32x16_bf16 a[48:63], a[236:239], v[224:227], a[48:63]
    buffer_load_dwordx4 a[172:175], v4, s[92:95], s7 offen offset:3072 sc1
    v_exp_f32 v194, v146
    v_add_f32 v241, v192, v193
    v_mfma_f32_32x32x16_bf16 a[0:15], a[240:243], v[228:231], a[0:15]
    buffer_load_dwordx4 a[176:179], v5, s[92:95], s7 offen offset:0 sc1
    v_exp_f32 v195, v147
    v_add_f32 v241, v241, v194
    v_mfma_f32_32x32x16_bf16 a[16:31], a[244:247], v[228:231], a[16:31]
    buffer_load_dwordx4 a[180:183], v5, s[92:95], s7 offen offset:1024 sc1
    v_exp_f32 v196, v148
    v_add_f32 v241, v241, v195
    v_mfma_f32_32x32x16_bf16 a[32:47], a[248:251], v[228:231], a[32:47]
    buffer_load_dwordx4 a[184:187], v5, s[92:95], s7 offen offset:2048 sc1
    v_exp_f32 v197, v149
    v_add_f32 v241, v241, v196
    v_mfma_f32_32x32x16_bf16 a[48:63], a[252:255], v[228:231], a[48:63]
    buffer_load_dwordx4 a[188:191], v5, s[92:95], s7 offen offset:3072 sc1
    v_exp_f32 v198, v150
    v_add_f32 v241, v241, v197
    s_barrier
    buffer_load_dwordx2 v[54:55], v51, s[92:95], 0 offen offset:2048 sc1
    s_waitcnt vmcnt(21)
    v_mfma_f32_32x32x16_bf16 v[128:143], a[128:131], v[64:67], v[160:175]
    v_exp_f32 v199, v151
    v_exp_f32 v200, v152
    v_add_f32 v241, v241, v198
    v_mfma_f32_32x32x16_bf16 v[128:143], a[132:135], v[68:71], v[128:143]
    v_exp_f32 v201, v153
    v_add_f32 v241, v241, v199
    v_cvt_pk_bf16_f32 v232, v192, v193
    v_mfma_f32_32x32x16_bf16 v[128:143], a[136:139], v[72:75], v[128:143]
    v_exp_f32 v202, v154
    v_exp_f32 v203, v155
    v_add_f32 v241, v241, v200
    v_mfma_f32_32x32x16_bf16 v[128:143], a[140:143], v[76:79], v[128:143]
    v_exp_f32 v204, v156
    v_add_f32 v241, v241, v201
    v_cvt_pk_bf16_f32 v233, v194, v195
    v_add_f32 v241, v241, v202
    s_waitcnt vmcnt(17)
    v_mfma_f32_32x32x16_bf16 v[128:143], a[144:147], v[80:83], v[128:143]
    v_exp_f32 v205, v157
    v_add_f32 v241, v241, v203
    v_cvt_pk_bf16_f32 v234, v196, v197
    v_mfma_f32_32x32x16_bf16 v[128:143], a[148:151], v[84:87], v[128:143]
    v_exp_f32 v206, v158
    v_add_f32 v241, v241, v204
    v_cvt_pk_bf16_f32 v235, v198, v199
    v_add_f32 v241, v241, v205
    v_mfma_f32_32x32x16_bf16 v[128:143], a[152:155], v[88:91], v[128:143]
    v_exp_f32 v207, v159
    v_add_f32 v241, v241, v206
    v_add_f32 v241, v241, v207
    v_cmp_lt_f32 vcc, s6, v241
    v_mfma_f32_32x32x16_bf16 v[128:143], a[156:159], v[92:95], v[128:143]
    s_cbranch_vccnz L_stub_10
L_ret_10:
    s_nop 0
    s_add_u32 s8, s12, 0x40000
    v_mfma_f32_32x32x16_bf16 a[64:79], a[224:227], v[232:235], a[64:79]
    buffer_load_dwordx4 a[224:227], v6, s[92:95], s8 offen offset:0 sc1
    v_cvt_pk_bf16_f32 v236, v200, v201
    v_cvt_pk_bf16_f32 v237, v202, v203
    v_mfma_f32_32x32x16_bf16 a[80:95], a[228:231], v[232:235], a[80:95]
    buffer_load_dwordx4 a[228:231], v6, s[92:95], s8 offen offset:1024 sc1
    v_cvt_pk_bf16_f32 v238, v204, v205
    v_cvt_pk_bf16_f32 v239, v206, v207
    v_add_f32 v243, v243, v241
    v_mfma_f32_32x32x16_bf16 a[96:111], a[232:235], v[232:235], a[96:111]
    buffer_load_dwordx4 a[232:235], v6, s[92:95], s8 offen offset:2048 sc1
    v_exp_f32 v192, v128
    v_exp_f32 v193, v129
    v_mfma_f32_32x32x16_bf16 a[112:127], a[236:239], v[232:235], a[112:127]
    buffer_load_dwordx4 a[236:239], v6, s[92:95], s8 offen offset:3072 sc1
    v_exp_f32 v194, v130
    v_add_f32 v240, v192, v193
    v_mfma_f32_32x32x16_bf16 a[64:79], a[240:243], v[236:239], a[64:79]
    buffer_load_dwordx4 a[240:243], v7, s[92:95], s8 offen offset:0 sc1
    v_exp_f32 v195, v131
    v_add_f32 v240, v240, v194
    v_mfma_f32_32x32x16_bf16 a[80:95], a[244:247], v[236:239], a[80:95]
    buffer_load_dwordx4 a[244:247], v7, s[92:95], s8 offen offset:1024 sc1
    v_exp_f32 v196, v132
    v_add_f32 v240, v240, v195
    v_mfma_f32_32x32x16_bf16 a[96:111], a[248:251], v[236:239], a[96:111]
    buffer_load_dwordx4 a[248:251], v7, s[92:95], s8 offen offset:2048 sc1
    v_exp_f32 v197, v133
    v_add_f32 v240, v240, v196
    v_mfma_f32_32x32x16_bf16 a[112:127], a[252:255], v[236:239], a[112:127]
    buffer_load_dwordx4 a[252:255], v7, s[92:95], s8 offen offset:3072 sc1
    v_exp_f32 v198, v134
    v_add_f32 v240, v240, v197
    v_mfma_f32_32x32x16_bf16 v[144:159], a[128:131], v[96:99], v[176:191]
    v_exp_f32 v199, v135
    v_exp_f32 v200, v136
    v_add_f32 v240, v240, v198
    v_mfma_f32_32x32x16_bf16 v[144:159], a[132:135], v[100:103], v[144:159]
    v_exp_f32 v201, v137
    v_add_f32 v240, v240, v199
    v_cvt_pk_bf16_f32 v224, v192, v193
    v_mfma_f32_32x32x16_bf16 v[144:159], a[136:139], v[104:107], v[144:159]
    v_exp_f32 v202, v138
    v_exp_f32 v203, v139
    v_add_f32 v240, v240, v200
    v_mfma_f32_32x32x16_bf16 v[144:159], a[140:143], v[108:111], v[144:159]
    v_exp_f32 v204, v140
    v_add_f32 v240, v240, v201
    v_cvt_pk_bf16_f32 v225, v194, v195
    v_add_f32 v240, v240, v202
    v_mfma_f32_32x32x16_bf16 v[144:159], a[144:147], v[112:115], v[144:159]
    v_exp_f32 v205, v141
    v_add_f32 v240, v240, v203
    v_cvt_pk_bf16_f32 v226, v196, v197
    v_mfma_f32_32x32x16_bf16 v[144:159], a[148:151], v[116:119], v[144:159]
    v_exp_f32 v206, v142
    v_add_f32 v240, v240, v204
    v_cvt_pk_bf16_f32 v227, v198, v199
    v_add_f32 v240, v240, v205
    v_mfma_f32_32x32x16_bf16 v[144:159], a[152:155], v[120:123], v[144:159]
    v_exp_f32 v207, v143
    v_add_f32 v240, v240, v206
    v_add_f32 v240, v240, v207
    v_cmp_lt_f32 vcc, s6, v240
    v_mfma_f32_32x32x16_bf16 v[144:159], a[156:159], v[124:127], v[144:159]
    s_cbranch_vccnz L_stub_11
L_ret_11:
    s_nop 0
    s_waitcnt vmcnt(8)
    v_cmp_ne_u64 vcc, s[96:97], v[54:55]
    s_cbranch_vccnz L_spin_2
L_spinret_2:
    s_add_u32 s7, s9, 0x80000
    v_mfma_f32_32x32x16_bf16 a[0:15], a[192:195], v[224:227], a[0:15]
    buffer_load_dwordx4 a[128:131], v4, s[92:95], s7 offen offset:0 sc1
    v_cvt_pk_bf16_f32 v228, v200, v201
    v_cvt_pk_bf16_f32 v229, v202, v203
    v_mfma_f32_32x32x16_bf16 a[16:31], a[196:199], v[224:227], a[16:31]
    buffer_load_dwordx4 a[132:135], v4, s[92:95], s7 offen offset:1024 sc1
    v_cvt_pk_bf16_f32 v230, v204, v205
    v_cvt_pk_bf16_f32 v231, v206, v207
    v_add_f32 v242, v242, v240
    v_mfma_f32_32x32x16_bf16 a[32:47], a[200:203], v[224:227], a[32:47]
    buffer_load_dwordx4 a[136:139], v4, s[92:95], s7 offen offset:2048 sc1
    v_exp_f32 v192, v144
    v_exp_f32 v193, v145
    v_mfma_f32_32x32x16_bf16 a[48:63], a[204:207], v[224:227], a[48:63]
    buffer_load_dwordx4 a[140:143], v4, s[92:95], s7 offen offset:3072 sc1
    v_exp_f32 v194, v146
    v_add_f32 v241, v192, v193
    v_mfma_f32_32x32x16_bf16 a[0:15], a[208:211], v[228:231], a[0:15]
    buffer_load_dwordx4 a[144:147], v5, s[92:95], s7 offen offset:0 sc1
    v_exp_f32 v195, v147
    v_add_f32 v241, v241, v194
    v_mfma_f32_32x32x16_bf16 a[16:31], a[212:215], v[228:231], a[16:31]
    buffer_load_dwordx4 a[148:151], v5, s[92:95], s7 offen offset:1024 sc1
    v_exp_f32 v196, v148
    v_add_f32 v241, v241, v195
    v_mfma_f32_32x32x16_bf16 a[32:47], a[216:219], v[228:231], a[32:47]
    buffer_load_dwordx4 a[152:155], v5, s[92:95], s7 offen offset:2048 sc1
    v_exp_f32 v197, v149
    v_add_f32 v241, v241, v196
    v_mfma_f32_32x32x16_bf16 a[48:63], a[220:223], v[228:231], a[48:63]
    buffer_load_dwordx4 a[156:159], v5, s[92:95], s7 offen offset:3072 sc1
    v_exp_f32 v198, v150
    v_add_f32 v241, v241, v197
    v_mfma_f32_32x32x16_bf16 v[128:143], a[160:163], v[64:67], v[160:175]
    v_exp_f32 v199, v151
    v_exp_f32 v200, v152
    v_add_f32 v241, v241, v198
    v_mfma_f32_32x32x16_bf16 v[128:143], a[164:167], v[68:71], v[128:143]
    v_exp_f32 v201, v153
    v_add_f32 v241, v241, v199
    v_cvt_pk_bf16_f32 v232, v192, v193
    v_mfma_f32_32x32x16_bf16 v[128:143], a[168:171], v[72:75], v[128:143]
    v_exp_f32 v202, v154
    v_exp_f32 v203, v155
    v_add_f32 v241, v241, v200
    v_mfma_f32_32x32x16_bf16 v[128:143], a[172:175], v[76:79], v[128:143]
    v_exp_f32 v204, v156
    v_add_f32 v241, v241, v201
    v_cvt_pk_bf16_f32 v233, v194, v195
    v_add_f32 v241, v241, v202
    v_mfma_f32_32x32x16_bf16 v[128:143], a[176:179], v[80:83], v[128:143]
    v_exp_f32 v205, v157
    v_add_f32 v241, v241, v203
    v_cvt_pk_bf16_f32 v234, v196, v197
    v_mfma_f32_32x32x16_bf16 v[128:143], a[180:183], v[84:87], v[128:143]
    v_exp_f32 v206, v158
    v_add_f32 v241, v241, v204
    v_cvt_pk_bf16_f32 v235, v198, v199
    v_add_f32 v241, v241, v205
    v_mfma_f32_32x32x16_bf16 v[128:143], a[184:187], v[88:91], v[128:143]
    v_exp_f32 v207, v159
    v_add_f32 v241, v241, v206
    v_add_f32 v241, v241, v207
    v_cmp_lt_f32 vcc, s6, v241
    v_mfma_f32_32x32x16_bf16 v[128:143], a[188:191], v[92:95], v[128:143]
    s_cbranch_vccnz L_stub_12
L_ret_12:
    s_nop 0
    s_add_u32 s8, s9, 0x80000
    v_mfma_f32_32x32x16_bf16 a[64:79], a[192:195], v[232:235], a[64:79]
    buffer_load_dwordx4 a[192:195], v6, s[92:95], s8 offen offset:0 sc1
    v_cvt_pk_bf16_f32 v236, v200, v201
    v_cvt_pk_bf16_f32 v237, v202, v203
    v_mfma_f32_32x32x16_bf16 a[80:95], a[196:199], v[232:235], a[80:95]
    buffer_load_dwordx4 a[196:199], v6, s[92:95], s8 offen offset:1024 sc1
    v_cvt_pk_bf16_f32 v238, v204, v205
    v_cvt_pk_bf16_f32 v239, v206, v207
    v_add_f32 v243, v243, v241
    v_mfma_f32_32x32x16_bf16 a[96:111], a[200:203], v[232:235], a[96:111]
    buffer_load_dwordx4 a[200:203], v6, s[92:95], s8 offen offset:2048 sc1
    v_exp_f32 v192, v128
    v_exp_f32 v193, v129
    v_mfma_f32_32x32x16_bf16 a[112:127], a[204:207], v[232:235], a[112:127]
    buffer_load_dwordx4 a[204:207], v6, s[92:95], s8 offen offset:3072 sc1
    v_exp_f32 v194, v130
    v_add_f32 v240, v192, v193
    v_mfma_f32_32x32x16_bf16 a[64:79], a[208:211], v[236:239], a[64:79]
    buffer_load_dwordx4 a[208:211], v7, s[92:95], s8 offen offset:0 sc1
    v_exp_f32 v195, v131
    v_add_f32 v240, v240, v194
    v_mfma_f32_32x32x16_bf16 a[80:95], a[212:215], v[236:239], a[80:95]
    buffer_load_dwordx4 a[212:215], v7, s[92:95], s8 offen offset:1024 sc1
    v_exp_f32 v196, v132
    v_add_f32 v240, v240, v195
    v_mfma_f32_32x32x16_bf16 a[96:111], a[216:219], v[236:239], a[96:111]
    buffer_load_dwordx4 a[216:219], v7, s[92:95], s8 offen offset:2048 sc1
    v_exp_f32 v197, v133
    v_add_f32 v240, v240, v196
    v_mfma_f32_32x32x16_bf16 a[112:127], a[220:223], v[236:239], a[112:127]
    buffer_load_dwordx4 a[220:223], v7, s[92:95], s8 offen offset:3072 sc1
    v_exp_f32 v198, v134
    v_add_f32 v240, v240, v197
    v_mfma_f32_32x32x16_bf16 v[144:159], a[160:163], v[96:99], v[176:191]
    v_exp_f32 v199, v135
    v_exp_f32 v200, v136
    v_add_f32 v240, v240, v198
    v_mfma_f32_32x32x16_bf16 v[144:159], a[164:167], v[100:103], v[144:159]
    v_exp_f32 v201, v137
    v_add_f32 v240, v240, v199
    v_cvt_pk_bf16_f32 v224, v192, v193
    v_mfma_f32_32x32x16_bf16 v[144:159], a[168:171], v[104:107], v[144:159]
    v_exp_f32 v202, v138
    v_exp_f32 v203, v139
    v_add_f32 v240, v240, v200
    v_mfma_f32_32x32x16_bf16 v[144:159], a[172:175], v[108:111], v[144:159]
    v_exp_f32 v204, v140
    v_add_f32 v240, v240, v201
    v_cvt_pk_bf16_f32 v225, v194, v195
    v_add_f32 v240, v240, v202
    v_mfma_f32_32x32x16_bf16 v[144:159], a[176:179], v[112:115], v[144:159]
    v_exp_f32 v205, v141
    v_add_f32 v240, v240, v203
    v_cvt_pk_bf16_f32 v226, v196, v197
    v_mfma_f32_32x32x16_bf16 v[144:159], a[180:183], v[116:119], v[144:159]
    v_exp_f32 v206, v142
    v_add_f32 v240, v240, v204
    v_cvt_pk_bf16_f32 v227, v198, v199
    v_add_f32 v240, v240, v205
    v_mfma_f32_32x32x16_bf16 v[144:159], a[184:187], v[120:123], v[144:159]
    v_exp_f32 v207, v143
    v_add_f32 v240, v240, v206
    v_add_f32 v240, v240, v207
    v_cmp_lt_f32 vcc, s6, v240
    v_mfma_f32_32x32x16_bf16 v[144:159], a[188:191], v[124:127], v[144:159]
    s_cbranch_vccnz L_stub_13
L_ret_13:
    s_nop 0
    s_waitcnt vmcnt(16)
    s_add_u32 s7, s10, 0x80000
    v_mfma_f32_32x32x16_bf16 a[0:15], a[224:227], v[224:227], a[0:15]
    buffer_load_dwordx4 a[160:163], v4, s[92:95], s7 offen offset:0 sc1
    v_cvt_pk_bf16_f32 v228, v200, v201
    v_cvt_pk_bf16_f32 v229, v202, v203
    v_mfma_f32_32x32x16_bf16 a[16:31], a[228:231], v[224:227], a[16:31]
    buffer_load_dwordx4 a[164:167], v4, s[92:95], s7 offen offset:1024 sc1
    v_cvt_pk_bf16_f32 v230, v204, v205
    v_cvt_pk_bf16_f32 v231, v206, v207
    v_add_f32 v242, v242, v240
    v_mfma_f32_32x32x16_bf16 a[32:47], a[232:235], v[224:227], a[32:47]
    buffer_load_dwordx4 a[168:171], v4, s[92:95], s7 offen offset:2048 sc1
    v_exp_f32 v192, v144
    v_exp_f32 v193, v145
    v_mfma_f32_32x32x16_bf16 a[48:63], a[236:239], v[224:227], a[48:63]
    buffer_load_dwordx4 a[172:175], v4, s[92:95], s7 offen offset:3072 sc1
    v_exp_f32 v194, v146
    v_add_f32 v241, v192, v193
    v_mfma_f32_32x32x16_bf16 a[0:15], a[240:243], v[228:231], a[0:15]
    buffer_load_dwordx4 a[176:179], v5, s[92:95], s7 offen offset:0 sc1
    v_exp_f32 v195, v147
    v_add_f32 v241, v241, v194
    v_mfma_f32_32x32x16_bf16 a[16:31], a[244:247], v[228:231], a[16:31]
    buffer_load_dwordx4 a[180:183], v5, s[92:95], s7 offen offset:1024 sc1
    v_exp_f32 v196, v148
    v_add_f32 v241, v241, v195
    v_mfma_f32_32x32x16_bf16 a[32:47], a[248:251], v[228:231], a[32:47]
    buffer_load_dwordx4 a[184:187], v5, s[92:95], s7 offen offset:2048 sc1
    v_exp_f32 v197, v149
    v_add_f32 v241, v241, v196
    v_mfma_f32_32x32x16_bf16 a[48:63], a[252:255], v[228:231], a[48:63]
    buffer_load_dwordx4 a[188:191], v5, s[92:95], s7 offen offset:3072 sc1
    v_exp_f32 v198, v150
    v_add_f32 v241, v241, v197
    s_waitcnt vmcnt(20)
    v_mfma_f32_32x32x16_bf16 v[128:143], a[128:131], v[64:67], v[160:175]
    v_exp_f32 v199, v151
    v_exp_f32 v200, v152
    v_add_f32 v241, v241, v198
    v_mfma_f32_32x32x16_bf16 v[128:143], a[132:135], v[68:71], v[128:143]
    v_exp_f32 v201, v153
    v_add_f32 v241, v241, v199
    v_cvt_pk_bf16_f32 v232, v192, v193
    v_mfma_f32_32x32x16_bf16 v[128:143], a[136:139], v[72:75], v[128:143]
    v_exp_f32 v202, v154
    v_exp_f32 v203, v155
    v_add_f32 v241, v241, v200
    v_mfma_f32_32x32x16_bf16 v[128:143], a[140:143], v[76:79], v[128:143]
    v_exp_f32 v204, v156
    v_add_f32 v241, v241, v201
    v_cvt_pk_bf16_f32 v233, v194, v195
    v_add_f32 v241, v241, v202
    s_waitcnt vmcnt(16)
    v_mfma_f32_32x32x16_bf16 v[128:143], a[144:147], v[80:83], v[128:143]
    v_exp_f32 v205, v157
    v_add_f32 v241, v241, v203
    v_cvt_pk_bf16_f32 v234, v196, v197
    v_mfma_f32_32x32x16_bf16 v[128:143], a[148:151], v[84:87], v[128:143]
    v_exp_f32 v206, v158
    v_add_f32 v241, v241, v204
    v_cvt_pk_bf16_f32 v235, v198, v199
    v_add_f32 v241, v241, v205
    v_mfma_f32_32x32x16_bf16 v[128:143], a[152:155], v[88:91], v[128:143]
    v_exp_f32 v207, v159
    v_add_f32 v241, v241, v206
    v_add_f32 v241, v241, v207
    v_cmp_lt_f32 vcc, s6, v241
    v_mfma_f32_32x32x16_bf16 v[128:143], a[156:159], v[92:95], v[128:143]
    s_cbranch_vccnz L_stub_14
L_ret_14:
    s_nop 0
    s_add_u32 s8, s10, 0x80000
    v_mfma_f32_32x32x16_bf16 a[64:79], a[224:227], v[232:235], a[64:79]
    buffer_load_dwordx4 a[224:227], v6, s[92:95], s8 offen offset:0 sc1
    v_cvt_pk_bf16_f32 v236, v200, v201
    v_cvt_pk_bf16_f32 v237, v202, v203
    v_mfma_f32_32x32x16_bf16 a[80:95], a[228:231], v[232:235], a[80:95]
    buffer_load_dwordx4 a[228:231], v6, s[92:95], s8 offen offset:1024 sc1
    v_cvt_pk_bf16_f32 v238, v204, v205
    v_cvt_pk_bf16_f32 v239, v206, v207
    v_add_f32 v243, v243, v241
    v_mfma_f32_32x32x16_bf16 a[96:111], a[232:235], v[232:235], a[96:111]
    buffer_load_dwordx4 a[232:235], v6, s[92:95], s8 offen offset:2048 sc1
    v_exp_f32 v192, v128
    v_exp_f32 v193, v129
    v_mfma_f32_32x32x16_bf16 a[112:127], a[236:239], v[232:235], a[112:127]
    buffer_load_dwordx4 a[236:239], v6, s[92:95], s8 offen offset:3072 sc1
    v_exp_f32 v194, v130
    v_add_f32 v240, v192, v193
    v_mfma_f32_32x32x16_bf16 a[64:79], a[240:243], v[236:239], a[64:79]
    buffer_load_dwordx4 a[240:243], v7, s[92:95], s8 offen offset:0 sc1
    v_exp_f32 v195, v131
    v_add_f32 v240, v240, v194
    v_mfma_f32_32x32x16_bf16 a[80:95], a[244:247], v[236:239], a[80:95]
    buffer_load_dwordx4 a[244:247], v7, s[92:95], s8 offen offset:1024 sc1
    v_exp_f32 v196, v132
    v_add_f32 v240, v240, v195
    v_mfma_f32_32x32x16_bf16 a[96:111], a[248:251], v[236:239], a[96:111]
    buffer_load_dwordx4 a[248:251], v7, s[92:95], s8 offen offset:2048 sc1
    v_exp_f32 v197, v133
    v_add_f32 v240, v240, v196
    v_mfma_f32_32x32x16_bf16 a[112:127], a[252:255], v[236:239], a[112:127]
    buffer_load_dwordx4 a[252:255], v7, s[92:95], s8 offen offset:3072 sc1
    v_exp_f32 v198, v134
    v_add_f32 v240, v240, v197
    v_mfma_f32_32x32x16_bf16 v[144:159], a[128:131], v[96:99], v[176:191]
    v_exp_f32 v199, v135
    v_exp_f32 v200, v136
    v_add_f32 v240, v240, v198
    v_mfma_f32_32x32x16_bf16 v[144:159], a[132:135], v[100:103], v[144:159]
    v_exp_f32 v201, v137
    v_add_f32 v240, v240, v199
    v_cvt_pk_bf16_f32 v224, v192, v193
    v_mfma_f32_32x32x16_bf16 v[144:159], a[136:139], v[104:107], v[144:159]
    v_exp_f32 v202, v138
    v_exp_f32 v203, v139
    v_add_f32 v240, v240, v200
    v_mfma_f32_32x32x16_bf16 v[144:159], a[140:143], v[108:111], v[144:159]
    v_exp_f32 v204, v140
    v_add_f32 v240, v240, v201
    v_cvt_pk_bf16_f32 v225, v194, v195
    v_add_f32 v240, v240, v202
    v_mfma_f32_32x32x16_bf16 v[144:159], a[144:147], v[112:115], v[144:159]
    v_exp_f32 v205, v141
    v_add_f32 v240, v240, v203
    v_cvt_pk_bf16_f32 v226, v196, v197
    v_mfma_f32_32x32x16_bf16 v[144:159], a[148:151], v[116:119], v[144:159]
    v_exp_f32 v206, v142
    v_add_f32 v240, v240, v204
    v_cvt_pk_bf16_f32 v227, v198, v199
    v_add_f32 v240, v240, v205
    v_mfma_f32_32x32x16_bf16 v[144:159], a[152:155], v[120:123], v[144:159]
    v_exp_f32 v207, v143
    v_add_f32 v240, v240, v206
    v_add_f32 v240, v240, v207
    v_cmp_lt_f32 vcc, s6, v240
    v_mfma_f32_32x32x16_bf16 v[144:159], a[156:159], v[124:127], v[144:159]
    s_cbranch_vccnz L_stub_15
L_ret_15:
    s_nop 0
    s_waitcnt vmcnt(16)
    s_add_u32 s7, s11, 0x80000
    v_mfma_f32_32x32x16_bf16 a[0:15], a[192:195], v[224:227], a[0:15]
    buffer_load_dwordx4 a[128:131], v4, s[92:95], s7 offen offset:0 sc1
    v_cvt_pk_bf16_f32 v228, v200, v201
    v_cvt_pk_bf16_f32 v229, v202, v203
    v_mfma_f32_32x32x16_bf16 a[16:31], a[196:199], v[224:227], a[16:31]
    buffer_load_dwordx4 a[132:135], v4, s[92:95], s7 offen offset:1024 sc1
    v_cvt_pk_bf16_f32 v230, v204, v205
    v_cvt_pk_bf16_f32 v231, v206, v207
    v_add_f32 v242, v242, v240
    v_mfma_f32_32x32x16_bf16 a[32:47], a[200:203], v[224:227], a[32:47]
    buffer_load_dwordx4 a[136:139], v4, s[92:95], s7 offen offset:2048 sc1
    v_exp_f32 v192, v144
    v_exp_f32 v193, v145
    v_mfma_f32_32x32x16_bf16 a[48:63], a[204:207], v[224:227], a[48:63]
    buffer_load_dwordx4 a[140:143], v4, s[92:95], s7 offen offset:3072 sc1
    v_exp_f32 v194, v146
    v_add_f32 v241, v192, v193
    v_mfma_f32_32x32x16_bf16 a[0:15], a[208:211], v[228:231], a[0:15]
    buffer_load_dwordx4 a[144:147], v5, s[92:95], s7 offen offset:0 sc1
    v_exp_f32 v195, v147
    v_add_f32 v241, v241, v194
    v_mfma_f32_32x32x16_bf16 a[16:31], a[212:215], v[228:231], a[16:31]
    buffer_load_dwordx4 a[148:151], v5, s[92:95], s7 offen offset:1024 sc1
    v_exp_f32 v196, v148
    v_add_f32 v241, v241, v195
    v_mfma_f32_32x32x16_bf16 a[32:47], a[216:219], v[228:231], a[32:47]
    buffer_load_dwordx4 a[152:155], v5, s[92:95], s7 offen offset:2048 sc1
    v_exp_f32 v197, v149
    v_add_f32 v241, v241, v196
    v_mfma_f32_32x32x16_bf16 a[48:63], a[220:223], v[228:231], a[48:63]
    buffer_load_dwordx4 a[156:159], v5, s[92:95], s7 offen offset:3072 sc1
    v_exp_f32 v198, v150
    v_add_f32 v241, v241, v197
    s_or_b32 s101, s2, s3
    s_cmp_eq_u32 s101, 0
    s_cbranch_scc1 L_epoch1
L_epochret1:
    s_waitcnt vmcnt(20)
    v_mfma_f32_32x32x16_bf16 v[128:143], a[160:163], v[64:67], v[160:175]
    v_exp_f32 v199, v151
    v_exp_f32 v200, v152
    v_add_f32 v241, v241, v198
    v_mfma_f32_32x32x16_bf16 v[128:143], a[164:167], v[68:71], v[128:143]
    v_exp_f32 v201, v153
    v_add_f32 v241, v241, v199
    v_cvt_pk_bf16_f32 v232, v192, v193
    v_mfma_f32_32x32x16_bf16 v[128:143], a[168:171], v[72:75], v[128:143]
    v_exp_f32 v202, v154
    v_exp_f32 v203, v155
    v_add_f32 v241, v241, v200
    v_mfma_f32_32x32x16_bf16 v[128:143], a[172:175], v[76:79], v[128:143]
    v_exp_f32 v204, v156
    v_add_f32 v241, v241, v201
    v_cvt_pk_bf16_f32 v233, v194, v195
    v_add_f32 v241, v241, v202
    s_waitcnt vmcnt(16)
    v_mfma_f32_32x32x16_bf16 v[128:143], a[176:179], v[80:83], v[128:143]
    v_exp_f32 v205, v157
    v_add_f32 v241, v241, v203
    v_cvt_pk_bf16_f32 v234, v196, v197
    v_mfma_f32_32x32x16_bf16 v[128:143], a[180:183], v[84:87], v[128:143]
    v_exp_f32 v206, v158
    v_add_f32 v241, v241, v204
    v_cvt_pk_bf16_f32 v235, v198, v199
    v_add_f32 v241, v241, v205
    v_mfma_f32_32x32x16_bf16 v[128:143], a[184:187], v[88:91], v[128:143]
    v_exp_f32 v207, v159
    v_add_f32 v241, v241, v206
    v_add_f32 v241, v241, v207
    v_cmp_lt_f32 vcc, s6, v241
    v_mfma_f32_32x32x16_bf16 v[128:143], a[188:191], v[92:95], v[128:143]
    s_cbranch_vccnz L_stub_16
L_ret_16:
    s_nop 0
    s_add_u32 s8, s11, 0x80000
    v_mfma_f32_32x32x16_bf16 a[64:79], a[192:195], v[232:235], a[64:79]
    buffer_load_dwordx4 a[192:195], v6, s[92:95], s8 offen offset:0 sc1
    v_cvt_pk_bf16_f32 v236, v200, v201
    v_cvt_pk_bf16_f32 v237, v202, v203
    v_mfma_f32_32x32x16_bf16 a[80:95], a[196:199], v[232:235], a[80:95]
    buffer_load_dwordx4 a[196:199], v6, s[92:95], s8 offen offset:1024 sc1
    v_cvt_pk_bf16_f32 v238, v204, v205
    v_cvt_pk_bf16_f32 v239, v206, v207
    v_add_f32 v243, v243, v241
    v_mfma_f32_32x32x16_bf16 a[96:111], a[200:203], v[232:235], a[96:111]
    buffer_load_dwordx4 a[200:203], v6, s[92:95], s8 offen offset:2048 sc1
    v_exp_f32 v192, v128
    v_exp_f32 v193, v129
    v_mfma_f32_32x32x16_bf16 a[112:127], a[204:207], v[232:235], a[112:127]
    buffer_load_dwordx4 a[204:207], v6, s[92:95], s8 offen offset:3072 sc1
    v_exp_f32 v194, v130
    v_add_f32 v240, v192, v193
    v_mfma_f32_32x32x16_bf16 a[64:79], a[208:211], v[236:239], a[64:79]
    buffer_load_dwordx4 a[208:211], v7, s[92:95], s8 offen offset:0 sc1
    v_exp_f32 v195, v131
    v_add_f32 v240, v240, v194
    v_mfma_f32_32x32x16_bf16 a[80:95], a[212:215], v[236:239], a[80:95]
    buffer_load_dwordx4 a[212:215], v7, s[92:95], s8 offen offset:1024 sc1
    v_exp_f32 v196, v132
    v_add_f32 v240, v240, v195
    v_mfma_f32_32x32x16_bf16 a[96:111], a[216:219], v[236:239], a[96:111]
    buffer_load_dwordx4 a[216:219], v7, s[92:95], s8 offen offset:2048 sc1
    v_exp_f32 v197, v133
    v_add_f32 v240, v240, v196
    v_mfma_f32_32x32x16_bf16 a[112:127], a[220:223], v[236:239], a[112:127]
    buffer_load_dwordx4 a[220:223], v7, s[92:95], s8 offen offset:3072 sc1
    v_exp_f32 v198, v134
    v_add_f32 v240, v240, v197
    v_mfma_f32_32x32x16_bf16 v[144:159], a[160:163], v[96:99], v[176:191]
    v_exp_f32 v199, v135
    v_exp_f32 v200, v136
    v_add_f32 v240, v240, v198
    v_mfma_f32_32x32x16_bf16 v[144:159], a[164:167], v[100:103], v[144:159]
    v_exp_f32 v201, v137
    v_add_f32 v240, v240, v199
    v_cvt_pk_bf16_f32 v224, v192, v193
    v_mfma_f32_32x32x16_bf16 v[144:159], a[168:171], v[104:107], v[144:159]
    v_exp_f32 v202, v138
    v_exp_f32 v203, v139
    v_add_f32 v240, v240, v200
    v_mfma_f32_32x32x16_bf16 v[144:159], a[172:175], v[108:111], v[144:159]
    v_exp_f32 v204, v140
    v_add_f32 v240, v240, v201
    v_cvt_pk_bf16_f32 v225, v194, v195
    v_add_f32 v240, v240, v202
    v_mfma_f32_32x32x16_bf16 v[144:159], a[176:179], v[112:115], v[144:159]
    v_exp_f32 v205, v141
    v_add_f32 v240, v240, v203
    v_cvt_pk_bf16_f32 v226, v196, v197
    v_mfma_f32_32x32x16_bf16 v[144:159], a[180:183], v[116:119], v[144:159]
    v_exp_f32 v206, v142
    v_add_f32 v240, v240, v204
    v_cvt_pk_bf16_f32 v227, v198, v199
    v_add_f32 v240, v240, v205
    v_mfma_f32_32x32x16_bf16 v[144:159], a[184:187], v[120:123], v[144:159]
    v_exp_f32 v207, v143
    v_add_f32 v240, v240, v206
    v_add_f32 v240, v240, v207
    v_cmp_lt_f32 vcc, s6, v240
    v_mfma_f32_32x32x16_bf16 v[144:159], a[188:191], v[124:127], v[144:159]
    s_cbranch_vccnz L_stub_17
L_ret_17:
    s_nop 0
    s_waitcnt vmcnt(16)
    s_add_u32 s7, s12, 0x80000
    v_mfma_f32_32x32x16_bf16 a[0:15], a[224:227], v[224:227], a[0:15]
    buffer_load_dwordx4 a[160:163], v4, s[92:95], s7 offen offset:0 sc1
    v_cvt_pk_bf16_f32 v228, v200, v201
    v_cvt_pk_bf16_f32 v229, v202, v203
    v_mfma_f32_32x32x16_bf16 a[16:31], a[228:231], v[224:227], a[16:31]
    buffer_load_dwordx4 a[164:167], v4, s[92:95], s7 offen offset:1024 sc1
    v_cvt_pk_bf16_f32 v230, v204, v205
    v_cvt_pk_bf16_f32 v231, v206, v207
    v_add_f32 v242, v242, v240
    v_mfma_f32_32x32x16_bf16 a[32:47], a[232:235], v[224:227], a[32:47]
    buffer_load_dwordx4 a[168:171], v4, s[92:95], s7 offen offset:2048 sc1
    v_exp_f32 v192, v144
    v_exp_f32 v193, v145
    v_mfma_f32_32x32x16_bf16 a[48:63], a[236:239], v[224:227], a[48:63]
    buffer_load_dwordx4 a[172:175], v4, s[92:95], s7 offen offset:3072 sc1
    v_exp_f32 v194, v146
    v_add_f32 v241, v192, v193
    v_mfma_f32_32x32x16_bf16 a[0:15], a[240:243], v[228:231], a[0:15]
    buffer_load_dwordx4 a[176:179], v5, s[92:95], s7 offen offset:0 sc1
    v_exp_f32 v195, v147
    v_add_f32 v241, v241, v194
    v_mfma_f32_32x32x16_bf16 a[16:31], a[244:247], v[228:231], a[16:31]
    buffer_load_dwordx4 a[180:183], v5, s[92:95], s7 offen offset:1024 sc1
    v_exp_f32 v196, v148
    v_add_f32 v241, v241, v195
    v_mfma_f32_32x32x16_bf16 a[32:47], a[248:251], v[228:231], a[32:47]
    buffer_load_dwordx4 a[184:187], v5, s[92:95], s7 offen offset:2048 sc1
    v_exp_f32 v197, v149
    v_add_f32 v241, v241, v196
    v_mfma_f32_32x32x16_bf16 a[48:63], a[252:255], v[228:231], a[48:63]
    buffer_load_dwordx4 a[188:191], v5, s[92:95], s7 offen offset:3072 sc1
    v_exp_f32 v198, v150
    v_add_f32 v241, v241, v197
    buffer_load_dwordx2 v[54:55], v51, s[92:95], 0 offen offset:3072 sc1
    s_waitcnt vmcnt(21)
    v_mfma_f32_32x32x16_bf16 v[128:143], a[128:131], v[64:67], v[160:175]
    v_exp_f32 v199, v151
    v_exp_f32 v200, v152
    v_add_f32 v241, v241, v198
    v_mfma_f32_32x32x16_bf16 v[128:143], a[132:135], v[68:71], v[128:143]
    v_exp_f32 v201, v153
    v_add_f32 v241, v241, v199
    v_cvt_pk_bf16_f32 v232, v192, v193
    v_mfma_f32_32x32x16_bf16 v[128:143], a[136:139], v[72:75], v[128:143]
    v_exp_f32 v202, v154
    v_exp_f32 v203, v155
    v_add_f32 v241, v241, v200
    v_mfma_f32_32x32x16_bf16 v[128:143], a[140:143], v[76:79], v[128:143]
    v_exp_f32 v204, v156
    v_add_f32 v241, v241, v201
    v_cvt_pk_bf16_f32 v233, v194, v195
    v_add_f32 v241, v241, v202
    s_waitcnt vmcnt(17)
    v_mfma_f32_32x32x16_bf16 v[128:143], a[144:147], v[80:83], v[128:143]
    v_exp_f32 v205, v157
    v_add_f32 v241, v241, v203
    v_cvt_pk_bf16_f32 v234, v196, v197
    v_mfma_f32_32x32x16_bf16 v[128:143], a[148:151], v[84:87], v[128:143]
    v_exp_f32 v206, v158
    v_add_f32 v241, v241, v204
    v_cvt_pk_bf16_f32 v235, v198, v199
    v_add_f32 v241, v241, v205
    v_mfma_f32_32x32x16_bf16 v[128:143], a[152:155], v[88:91], v[128:143]
    v_exp_f32 v207, v159
    v_add_f32 v241, v241, v206
    v_add_f32 v241, v241, v207
    v_cmp_lt_f32 vcc, s6, v241
    v_mfma_f32_32x32x16_bf16 v[128:143], a[156:159], v[92:95], v[128:143]
    s_cbranch_vccnz L_stub_18
L_ret_18:
    s_nop 0
    s_add_u32 s8, s12, 0x80000
    v_mfma_f32_32x32x16_bf16 a[64:79], a[224:227], v[232:235], a[64:79]
    buffer_load_dwordx4 a[224:227], v6, s[92:95], s8 offen offset:0 sc1
    v_cvt_pk_bf16_f32 v236, v200, v201
    v_cvt_pk_bf16_f32 v237, v202, v203
    v_mfma_f32_32x32x16_bf16 a[80:95], a[228:231], v[232:235], a[80:95]
    buffer_load_dwordx4 a[228:231], v6, s[92:95], s8 offen offset:1024 sc1
    v_cvt_pk_bf16_f32 v238, v204, v205
    v_cvt_pk_bf16_f32 v239, v206, v207
    v_add_f32 v243, v243, v241
    v_mfma_f32_32x32x16_bf16 a[96:111], a[232:235], v[232:235], a[96:111]
    buffer_load_dwordx4 a[232:235], v6, s[92:95], s8 offen offset:2048 sc1
    v_exp_f32 v192, v128
    v_exp_f32 v193, v129
    v_mfma_f32_32x32x16_bf16 a[112:127], a[236:239], v[232:235], a[112:127]
    buffer_load_dwordx4 a[236:239], v6, s[92:95], s8 offen offset:3072 sc1
    v_exp_f32 v194, v130
    v_add_f32 v240, v192, v193
    v_mfma_f32_32x32x16_bf16 a[64:79], a[240:243], v[236:239], a[64:79]
    buffer_load_dwordx4 a[240:243], v7, s[92:95], s8 offen offset:0 sc1
    v_exp_f32 v195, v131
    v_add_f32 v240, v240, v194
    v_mfma_f32_32x32x16_bf16 a[80:95], a[244:247], v[236:239], a[80:95]
    buffer_load_dwordx4 a[244:247], v7, s[92:95], s8 offen offset:1024 sc1
    v_exp_f32 v196, v132
    v_add_f32 v240, v240, v195
    v_mfma_f32_32x32x16_bf16 a[96:111], a[248:251], v[236:239], a[96:111]
    buffer_load_dwordx4 a[248:251], v7, s[92:95], s8 offen offset:2048 sc1
    v_exp_f32 v197, v133
    v_add_f32 v240, v240, v196
    v_mfma_f32_32x32x16_bf16 a[112:127], a[252:255], v[236:239], a[112:127]
    buffer_load_dwordx4 a[252:255], v7, s[92:95], s8 offen offset:3072 sc1
    v_exp_f32 v198, v134
    v_add_f32 v240, v240, v197
    v_mfma_f32_32x32x16_bf16 v[144:159], a[128:131], v[96:99], v[176:191]
    v_exp_f32 v199, v135
    v_exp_f32 v200, v136
    v_add_f32 v240, v240, v198
    v_mfma_f32_32x32x16_bf16 v[144:159], a[132:135], v[100:103], v[144:159]
    v_exp_f32 v201, v137
    v_add_f32 v240, v240, v199
    v_cvt_pk_bf16_f32 v224, v192, v193
    v_mfma_f32_32x32x16_bf16 v[144:159], a[136:139], v[104:107], v[144:159]
    v_exp_f32 v202, v138
    v_exp_f32 v203, v139
    v_add_f32 v240, v240, v200
    v_mfma_f32_32x32x16_bf16 v[144:159], a[140:143], v[108:111], v[144:159]
    v_exp_f32 v204, v140
    v_add_f32 v240, v240, v201
    v_cvt_pk_bf16_f32 v225, v194, v195
    v_add_f32 v240, v240, v202
    v_mfma_f32_32x32x16_bf16 v[144:159], a[144:147], v[112:115], v[144:159]
    v_exp_f32 v205, v141
    v_add_f32 v240, v240, v203
    v_cvt_pk_bf16_f32 v226, v196, v197
    v_mfma_f32_32x32x16_bf16 v[144:159], a[148:151], v[116:119], v[144:159]
    v_exp_f32 v206, v142
    v_add_f32 v240, v240, v204
    v_cvt_pk_bf16_f32 v227, v198, v199
    v_add_f32 v240, v240, v205
    v_mfma_f32_32x32x16_bf16 v[144:159], a[152:155], v[120:123], v[144:159]
    v_exp_f32 v207, v143
    v_add_f32 v240, v240, v206
    v_add_f32 v240, v240, v207
    v_cmp_lt_f32 vcc, s6, v240
    v_mfma_f32_32x32x16_bf16 v[144:159], a[156:159], v[124:127], v[144:159]
    s_cbranch_vccnz L_stub_19
L_ret_19:
    s_nop 0
    s_waitcnt vmcnt(8)
    v_cmp_ne_u64 vcc, s[96:97], v[54:55]
    s_cbranch_vccnz L_spin_3
L_spinret_3:
    s_add_u32 s7, s9, 0xc0000
    v_mfma_f32_32x32x16_bf16 a[0:15], a[192:195], v[224:227], a[0:15]
    buffer_load_dwordx4 a[128:131], v4, s[92:95], s7 offen offset:0 sc1
    v_cvt_pk_bf16_f32 v228, v200, v201
    v_cvt_pk_bf16_f32 v229, v202, v203
    v_mfma_f32_32x32x16_bf16 a[16:31], a[196:199], v[224:227], a[16:31]
    buffer_load_dwordx4 a[132:135], v4, s[92:95], s7 offen offset:1024 sc1
    v_cvt_pk_bf16_f32 v230, v204, v205
    v_cvt_pk_bf16_f32 v231, v206, v207
    v_add_f32 v242, v242, v240
    v_mfma_f32_32x32x16_bf16 a[32:47], a[200:203], v[224:227], a[32:47]
    buffer_load_dwordx4 a[136:139], v4, s[92:95], s7 offen offset:2048 sc1
    v_exp_f32 v192, v144
    v_exp_f32 v193, v145
    v_mfma_f32_32x32x16_bf16 a[48:63], a[204:207], v[224:227], a[48:63]
    buffer_load_dwordx4 a[140:143], v4, s[92:95], s7 offen offset:3072 sc1
    v_exp_f32 v194, v146
    v_add_f32 v241, v192, v193
    v_mfma_f32_32x32x16_bf16 a[0:15], a[208:211], v[228:231], a[0:15]
    buffer_load_dwordx4 a[144:147], v5, s[92:95], s7 offen offset:0 sc1
    v_exp_f32 v195, v147
    v_add_f32 v241, v241, v194
    v_mfma_f32_32x32x16_bf16 a[16:31], a[212:215], v[228:231], a[16:31]
    buffer_load_dwordx4 a[148:151], v5, s[92:95], s7 offen offset:1024 sc1
    v_exp_f32 v196, v148
    v_add_f32 v241, v241, v195
    v_mfma_f32_32x32x16_bf16 a[32:47], a[216:219], v[228:231], a[32:47]
    buffer_load_dwordx4 a[152:155], v5, s[92:95], s7 offen offset:2048 sc1
    v_exp_f32 v197, v149
    v_add_f32 v241, v241, v196
    v_mfma_f32_32x32x16_bf16 a[48:63], a[220:223], v[228:231], a[48:63]
    buffer_load_dwordx4 a[156:159], v5, s[92:95], s7 offen offset:3072 sc1
    v_exp_f32 v198, v150
    v_add_f32 v241, v241, v197
    v_mfma_f32_32x32x16_bf16 v[128:143], a[160:163], v[64:67], v[160:175]
    v_exp_f32 v199, v151
    v_exp_f32 v200, v152
    v_add_f32 v241, v241, v198
    v_mfma_f32_32x32x16_bf16 v[128:143], a[164:167], v[68:71], v[128:143]
    v_exp_f32 v201, v153
    v_add_f32 v241, v241, v199
    v_cvt_pk_bf16_f32 v232, v192, v193
    v_mfma_f32_32x32x16_bf16 v[128:143], a[168:171], v[72:75], v[128:143]
    v_exp_f32 v202, v154
    v_exp_f32 v203, v155
    v_add_f32 v241, v241, v200
    v_mfma_f32_32x32x16_bf16 v[128:143], a[172:175], v[76:79], v[128:143]
    v_exp_f32 v204, v156
    v_add_f32 v241, v241, v201
    v_cvt_pk_bf16_f32 v233, v194, v195
    v_add_f32 v241, v241, v202
    v_mfma_f32_32x32x16_bf16 v[128:143], a[176:179], v[80:83], v[128:143]
    v_exp_f32 v205, v157
    v_add_f32 v241, v241, v203
    v_cvt_pk_bf16_f32 v234, v196, v197
    v_mfma_f32_32x32x16_bf16 v[128:143], a[180:183], v[84:87], v[128:143]
    v_exp_f32 v206, v158
    v_add_f32 v241, v241, v204
    v_cvt_pk_bf16_f32 v235, v198, v199
    v_add_f32 v241, v241, v205
    v_mfma_f32_32x32x16_bf16 v[128:143], a[184:187], v[88:91], v[128:143]
    v_exp_f32 v207, v159
    v_add_f32 v241, v241, v206
    v_add_f32 v241, v241, v207
    v_cmp_lt_f32 vcc, s6, v241
    v_mfma_f32_32x32x16_bf16 v[128:143], a[188:191], v[92:95], v[128:143]
    s_cbranch_vccnz L_stub_20
L_ret_20:
    s_nop 0
    s_add_u32 s8, s9, 0xc0000
    v_mfma_f32_32x32x16_bf16 a[64:79], a[192:195], v[232:235], a[64:79]
    buffer_load_dwordx4 a[192:195], v6, s[92:95], s8 offen offset:0 sc1
    v_cvt_pk_bf16_f32 v236, v200, v201
    v_cvt_pk_bf16_f32 v237, v202, v203
    v_mfma_f32_32x32x16_bf16 a[80:95], a[196:199], v[232:235], a[80:95]
    buffer_load_dwordx4 a[196:199], v6, s[92:95], s8 offen offset:1024 sc1
    v_cvt_pk_bf16_f32 v238, v204, v205
    v_cvt_pk_bf16_f32 v239, v206, v207
    v_add_f32 v243, v243, v241
    v_mfma_f32_32x32x16_bf16 a[96:111], a[200:203], v[232:235], a[96:111]
    buffer_load_dwordx4 a[200:203], v6, s[92:95], s8 offen offset:2048 sc1
    v_exp_f32 v192, v128
    v_exp_f32 v193, v129
    v_mfma_f32_32x32x16_bf16 a[112:127], a[204:207], v[232:235], a[112:127]
    buffer_load_dwordx4 a[204:207], v6, s[92:95], s8 offen offset:3072 sc1
    v_exp_f32 v194, v130
    v_add_f32 v240, v192, v193
    v_mfma_f32_32x32x16_bf16 a[64:79], a[208:211], v[236:239], a[64:79]
    buffer_load_dwordx4 a[208:211], v7, s[92:95], s8 offen offset:0 sc1
    v_exp_f32 v195, v131
    v_add_f32 v240, v240, v194
    v_mfma_f32_32x32x16_bf16 a[80:95], a[212:215], v[236:239], a[80:95]
    buffer_load_dwordx4 a[212:215], v7, s[92:95], s8 offen offset:1024 sc1
    v_exp_f32 v196, v132
    v_add_f32 v240, v240, v195
    v_mfma_f32_32x32x16_bf16 a[96:111], a[216:219], v[236:239], a[96:111]
    buffer_load_dwordx4 a[216:219], v7, s[92:95], s8 offen offset:2048 sc1
    v_exp_f32 v197, v133
    v_add_f32 v240, v240, v196
    v_mfma_f32_32x32x16_bf16 a[112:127], a[220:223], v[236:239], a[112:127]
    buffer_load_dwordx4 a[220:223], v7, s[92:95], s8 offen offset:3072 sc1
    v_exp_f32 v198, v134
    v_add_f32 v240, v240, v197
    v_mfma_f32_32x32x16_bf16 v[144:159], a[160:163], v[96:99], v[176:191]
    v_exp_f32 v199, v135
    v_exp_f32 v200, v136
    v_add_f32 v240, v240, v198
    v_mfma_f32_32x32x16_bf16 v[144:159], a[164:167], v[100:103], v[144:159]
    v_exp_f32 v201, v137
    v_add_f32 v240, v240, v199
    v_cvt_pk_bf16_f32 v224, v192, v193
    v_mfma_f32_32x32x16_bf16 v[144:159], a[168:171], v[104:107], v[144:159]
    v_exp_f32 v202, v138
    v_exp_f32 v203, v139
    v_add_f32 v240, v240, v200
    v_mfma_f32_32x32x16_bf16 v[144:159], a[172:175], v[108:111], v[144:159]
    v_exp_f32 v204, v140
    v_add_f32 v240, v240, v201
    v_cvt_pk_bf16_f32 v225, v194, v195
    v_add_f32 v240, v240, v202
    v_mfma_f32_32x32x16_bf16 v[144:159], a[176:179], v[112:115], v[144:159]
    v_exp_f32 v205, v141
    v_add_f32 v240, v240, v203
    v_cvt_pk_bf16_f32 v226, v196, v197
    v_mfma_f32_32x32x16_bf16 v[144:159], a[180:183], v[116:119], v[144:159]
    v_exp_f32 v206, v142
    v_add_f32 v240, v240, v204
    v_cvt_pk_bf16_f32 v227, v198, v199
    v_add_f32 v240, v240, v205
    v_mfma_f32_32x32x16_bf16 v[144:159], a[184:187], v[120:123], v[144:159]
    v_exp_f32 v207, v143
    v_add_f32 v240, v240, v206
    v_add_f32 v240, v240, v207
    v_cmp_lt_f32 vcc, s6, v240
    v_mfma_f32_32x32x16_bf16 v[144:159], a[188:191], v[124:127], v[144:159]
    s_cbranch_vccnz L_stub_21
L_ret_21:
    s_nop 0
    s_waitcnt vmcnt(16)
    s_add_u32 s7, s10, 0xc0000
    v_mfma_f32_32x32x16_bf16 a[0:15], a[224:227], v[224:227], a[0:15]
    buffer_load_dwordx4 a[160:163], v4, s[92:95], s7 offen offset:0 sc1
    v_cvt_pk_bf16_f32 v228, v200, v201
    v_cvt_pk_bf16_f32 v229, v202, v203
    v_mfma_f32_32x32x16_bf16 a[16:31], a[228:231], v[224:227], a[16:31]
    buffer_load_dwordx4 a[164:167], v4, s[92:95], s7 offen offset:1024 sc1
    v_cvt_pk_bf16_f32 v230, v204, v205
    v_cvt_pk_bf16_f32 v231, v206, v207
    v_add_f32 v242, v242, v240
    v_mfma_f32_32x32x16_bf16 a[32:47], a[232:235], v[224:227], a[32:47]
    buffer_load_dwordx4 a[168:171], v4, s[92:95], s7 offen offset:2048 sc1
    v_exp_f32 v192, v144
    v_exp_f32 v193, v145
    v_mfma_f32_32x32x16_bf16 a[48:63], a[236:239], v[224:227], a[48:63]
    buffer_load_dwordx4 a[172:175], v4, s[92:95], s7 offen offset:3072 sc1
    v_exp_f32 v194, v146
    v_add_f32 v241, v192, v193
    v_mfma_f32_32x32x16_bf16 a[0:15], a[240:243], v[228:231], a[0:15]
    buffer_load_dwordx4 a[176:179], v5, s[92:95], s7 offen offset:0 sc1
    v_exp_f32 v195, v147
    v_add_f32 v241, v241, v194
    v_mfma_f32_32x32x16_bf16 a[16:31], a[244:247], v[228:231], a[16:31]
    buffer_load_dwordx4 a[180:183], v5, s[92:95], s7 offen offset:1024 sc1
    v_exp_f32 v196, v148
    v_add_f32 v241, v241, v195
    v_mfma_f32_32x32x16_bf16 a[32:47], a[248:251], v[228:231], a[32:47]
    buffer_load_dwordx4 a[184:187], v5, s[92:95], s7 offen offset:2048 sc1
    v_exp_f32 v197, v149
    v_add_f32 v241, v241, v196
    v_mfma_f32_32x32x16_bf16 a[48:63], a[252:255], v[228:231], a[48:63]
    buffer_load_dwordx4 a[188:191], v5, s[92:95], s7 offen offset:3072 sc1
    v_exp_f32 v198, v150
    v_add_f32 v241, v241, v197
    s_or_b32 s101, s2, s3
    s_cmp_eq_u32 s101, 0
    s_cbranch_scc1 L_epoch2
L_epochret2:
    s_waitcnt vmcnt(20)
    v_mfma_f32_32x32x16_bf16 v[128:143], a[128:131], v[64:67], v[160:175]
    v_exp_f32 v199, v151
    v_exp_f32 v200, v152
    v_add_f32 v241, v241, v198
    v_mfma_f32_32x32x16_bf16 v[128:143], a[132:135], v[68:71], v[128:143]
    v_exp_f32 v201, v153
    v_add_f32 v241, v241, v199
    v_cvt_pk_bf16_f32 v232, v192, v193
    v_mfma_f32_32x32x16_bf16 v[128:143], a[136:139], v[72:75], v[128:143]
    v_exp_f32 v202, v154
    v_exp_f32 v203, v155
    v_add_f32 v241, v241, v200
    v_mfma_f32_32x32x16_bf16 v[128:143], a[140:143], v[76:79], v[128:143]
    v_exp_f32 v204, v156
    v_add_f32 v241, v241, v201
    v_cvt_pk_bf16_f32 v233, v194, v195
    v_add_f32 v241, v241, v202
    s_waitcnt vmcnt(16)
    v_mfma_f32_32x32x16_bf16 v[128:143], a[144:147], v[80:83], v[128:143]
    v_exp_f32 v205, v157
    v_add_f32 v241, v241, v203
    v_cvt_pk_bf16_f32 v234, v196, v197
    v_mfma_f32_32x32x16_bf16 v[128:143], a[148:151], v[84:87], v[128:143]
    v_exp_f32 v206, v158
    v_add_f32 v241, v241, v204
    v_cvt_pk_bf16_f32 v235, v198, v199
    v_add_f32 v241, v241, v205
    v_mfma_f32_32x32x16_bf16 v[128:143], a[152:155], v[88:91], v[128:143]
    v_exp_f32 v207, v159
    v_add_f32 v241, v241, v206
    v_add_f32 v241, v241, v207
    v_cmp_lt_f32 vcc, s6, v241
    v_mfma_f32_32x32x16_bf16 v[128:143], a[156:159], v[92:95], v[128:143]
    s_cbranch_vccnz L_stub_22
L_ret_22:
    s_nop 0
    s_add_u32 s8, s10, 0xc0000
    v_mfma_f32_32x32x16_bf16 a[64:79], a[224:227], v[232:235], a[64:79]
    buffer_load_dwordx4 a[224:227], v6, s[92:95], s8 offen offset:0 sc1
    v_cvt_pk_bf16_f32 v236, v200, v201
    v_cvt_pk_bf16_f32 v237, v202, v203
    v_mfma_f32_32x32x16_bf16 a[80:95], a[228:231], v[232:235], a[80:95]
    buffer_load_dwordx4 a[228:231], v6, s[92:95], s8 offen offset:1024 sc1
    v_cvt_pk_bf16_f32 v238, v204, v205
    v_cvt_pk_bf16_f32 v239, v206, v207
    v_add_f32 v243, v243, v241
    v_mfma_f32_32x32x16_bf16 a[96:111], a[232:235], v[232:235], a[96:111]
    buffer_load_dwordx4 a[232:235], v6, s[92:95], s8 offen offset:2048 sc1
    v_exp_f32 v192, v128
    v_exp_f32 v193, v129
    v_mfma_f32_32x32x16_bf16 a[112:127], a[236:239], v[232:235], a[112:127]
    buffer_load_dwordx4 a[236:239], v6, s[92:95], s8 offen offset:3072 sc1
    v_exp_f32 v194, v130
    v_add_f32 v240, v192, v193
    v_mfma_f32_32x32x16_bf16 a[64:79], a[240:243], v[236:239], a[64:79]
    buffer_load_dwordx4 a[240:243], v7, s[92:95], s8 offen offset:0 sc1
    v_exp_f32 v195, v131
    v_add_f32 v240, v240, v194
    v_mfma_f32_32x32x16_bf16 a[80:95], a[244:247], v[236:239], a[80:95]
    buffer_load_dwordx4 a[244:247], v7, s[92:95], s8 offen offset:1024 sc1
    v_exp_f32 v196, v132
    v_add_f32 v240, v240, v195
    v_mfma_f32_32x32x16_bf16 a[96:111], a[248:251], v[236:239], a[96:111]
    buffer_load_dwordx4 a[248:251], v7, s[92:95], s8 offen offset:2048 sc1
    v_exp_f32 v197, v133
    v_add_f32 v240, v240, v196
    v_mfma_f32_32x32x16_bf16 a[112:127], a[252:255], v[236:239], a[112:127]
    buffer_load_dwordx4 a[252:255], v7, s[92:95], s8 offen offset:3072 sc1
    v_exp_f32 v198, v134
    v_add_f32 v240, v240, v197
    v_mfma_f32_32x32x16_bf16 v[144:159], a[128:131], v[96:99], v[176:191]
    v_exp_f32 v199, v135
    v_exp_f32 v200, v136
    v_add_f32 v240, v240, v198
    v_mfma_f32_32x32x16_bf16 v[144:159], a[132:135], v[100:103], v[144:159]
    v_exp_f32 v201, v137
    v_add_f32 v240, v240, v199
    v_cvt_pk_bf16_f32 v224, v192, v193
    v_mfma_f32_32x32x16_bf16 v[144:159], a[136:139], v[104:107], v[144:159]
    v_exp_f32 v202, v138
    v_exp_f32 v203, v139
    v_add_f32 v240, v240, v200
    v_mfma_f32_32x32x16_bf16 v[144:159], a[140:143], v[108:111], v[144:159]
    v_exp_f32 v204, v140
    v_add_f32 v240, v240, v201
    v_cvt_pk_bf16_f32 v225, v194, v195
    v_add_f32 v240, v240, v202
    v_mfma_f32_32x32x16_bf16 v[144:159], a[144:147], v[112:115], v[144:159]
    v_exp_f32 v205, v141
    v_add_f32 v240, v240, v203
    v_cvt_pk_bf16_f32 v226, v196, v197
    v_mfma_f32_32x32x16_bf16 v[144:159], a[148:151], v[116:119], v[144:159]
    v_exp_f32 v206, v142
    v_add_f32 v240, v240, v204
    v_cvt_pk_bf16_f32 v227, v198, v199
    v_add_f32 v240, v240, v205
    v_mfma_f32_32x32x16_bf16 v[144:159], a[152:155], v[120:123], v[144:159]
    v_exp_f32 v207, v143
    v_add_f32 v240, v240, v206
    v_add_f32 v240, v240, v207
    v_cmp_lt_f32 vcc, s6, v240
    v_mfma_f32_32x32x16_bf16 v[144:159], a[156:159], v[124:127], v[144:159]
    s_cbranch_vccnz L_stub_23
L_ret_23:
    s_nop 0
    s_waitcnt vmcnt(16)
    s_add_u32 s7, s11, 0xc0000
    v_mfma_f32_32x32x16_bf16 a[0:15], a[192:195], v[224:227], a[0:15]
    buffer_load_dwordx4 a[128:131], v4, s[92:95], s7 offen offset:0 sc1
    v_cvt_pk_bf16_f32 v228, v200, v201
    v_cvt_pk_bf16_f32 v229, v202, v203
    v_mfma_f32_32x32x16_bf16 a[16:31], a[196:199], v[224:227], a[16:31]
    buffer_load_dwordx4 a[132:135], v4, s[92:95], s7 offen offset:1024 sc1
    v_cvt_pk_bf16_f32 v230, v204, v205
    v_cvt_pk_bf16_f32 v231, v206, v207
    v_add_f32 v242, v242, v240
    v_mfma_f32_32x32x16_bf16 a[32:47], a[200:203], v[224:227], a[32:47]
    buffer_load_dwordx4 a[136:139], v4, s[92:95], s7 offen offset:2048 sc1
    v_exp_f32 v192, v144
    v_exp_f32 v193, v145
    v_mfma_f32_32x32x16_bf16 a[48:63], a[204:207], v[224:227], a[48:63]
    buffer_load_dwordx4 a[140:143], v4, s[92:95], s7 offen offset:3072 sc1
    v_exp_f32 v194, v146
    v_add_f32 v241, v192, v193
    v_mfma_f32_32x32x16_bf16 a[0:15], a[208:211], v[228:231], a[0:15]
    buffer_load_dwordx4 a[144:147], v5, s[92:95], s7 offen offset:0 sc1
    v_exp_f32 v195, v147
    v_add_f32 v241, v241, v194
    v_mfma_f32_32x32x16_bf16 a[16:31], a[212:215], v[228:231], a[16:31]
    buffer_load_dwordx4 a[148:151], v5, s[92:95], s7 offen offset:1024 sc1
    v_exp_f32 v196, v148
    v_add_f32 v241, v241, v195
    v_mfma_f32_32x32x16_bf16 a[32:47], a[216:219], v[228:231], a[32:47]
    buffer_load_dwordx4 a[152:155], v5, s[92:95], s7 offen offset:2048 sc1
    v_exp_f32 v197, v149
    v_add_f32 v241, v241, v196
    v_mfma_f32_32x32x16_bf16 a[48:63], a[220:223], v[228:231], a[48:63]
    buffer_load_dwordx4 a[156:159], v5, s[92:95], s7 offen offset:3072 sc1
    v_exp_f32 v198, v150
    v_add_f32 v241, v241, v197
    s_waitcnt vmcnt(20)
    v_mfma_f32_32x32x16_bf16 v[128:143], a[160:163], v[64:67], v[160:175]
    v_exp_f32 v199, v151
    v_exp_f32 v200, v152
    v_add_f32 v241, v241, v198
    v_mfma_f32_32x32x16_bf16 v[128:143], a[164:167], v[68:71], v[128:143]
    v_exp_f32 v201, v153
    v_add_f32 v241, v241, v199
    v_cvt_pk_bf16_f32 v232, v192, v193
    v_mfma_f32_32x32x16_bf16 v[128:143], a[168:171], v[72:75], v[128:143]
    v_exp_f32 v202, v154
    v_exp_f32 v203, v155
    v_add_f32 v241, v241, v200
    v_mfma_f32_32x32x16_bf16 v[128:143], a[172:175], v[76:79], v[128:143]
    v_exp_f32 v204, v156
    v_add_f32 v241, v241, v201
    v_cvt_pk_bf16_f32 v233, v194, v195
    v_add_f32 v241, v241, v202
    s_waitcnt vmcnt(16)
    v_mfma_f32_32x32x16_bf16 v[128:143], a[176:179], v[80:83], v[128:143]
    v_exp_f32 v205, v157
    v_add_f32 v241, v241, v203
    v_cvt_pk_bf16_f32 v234, v196, v197
    v_mfma_f32_32x32x16_bf16 v[128:143], a[180:183], v[84:87], v[128:143]
    v_exp_f32 v206, v158
    v_add_f32 v241, v241, v204
    v_cvt_pk_bf16_f32 v235, v198, v199
    v_add_f32 v241, v241, v205
    v_mfma_f32_32x32x16_bf16 v[128:143], a[184:187], v[88:91], v[128:143]
    v_exp_f32 v207, v159
    v_add_f32 v241, v241, v206
    v_add_f32 v241, v241, v207
    v_cmp_lt_f32 vcc, s6, v241
    v_mfma_f32_32x32x16_bf16 v[128:143], a[188:191], v[92:95], v[128:143]
    s_cbranch_vccnz L_stub_24
L_ret_24:
    s_nop 0
    s_add_u32 s8, s11, 0xc0000
    v_mfma_f32_32x32x16_bf16 a[64:79], a[192:195], v[232:235], a[64:79]
    buffer_load_dwordx4 a[192:195], v6, s[92:95], s8 offen offset:0 sc1
    v_cvt_pk_bf16_f32 v236, v200, v201
    v_cvt_pk_bf16_f32 v237, v202, v203
    v_mfma_f32_32x32x16_bf16 a[80:95], a[196:199], v[232:235], a[80:95]
    buffer_load_dwordx4 a[196:199], v6, s[92:95], s8 offen offset:1024 sc1
    v_cvt_pk_bf16_f32 v238, v204, v205
    v_cvt_pk_bf16_f32 v239, v206, v207
    v_add_f32 v243, v243, v241
    v_mfma_f32_32x32x16_bf16 a[96:111], a[200:203], v[232:235], a[96:111]
    buffer_load_dwordx4 a[200:203], v6, s[92:95], s8 offen offset:2048 sc1
    v_exp_f32 v192, v128
    v_exp_f32 v193, v129
    v_mfma_f32_32x32x16_bf16 a[112:127], a[204:207], v[232:235], a[112:127]
    buffer_load_dwordx4 a[204:207], v6, s[92:95], s8 offen offset:3072 sc1
    v_exp_f32 v194, v130
    v_add_f32 v240, v192, v193
    v_mfma_f32_32x32x16_bf16 a[64:79], a[208:211], v[236:239], a[64:79]
    buffer_load_dwordx4 a[208:211], v7, s[92:95], s8 offen offset:0 sc1
    v_exp_f32 v195, v131
    v_add_f32 v240, v240, v194
    v_mfma_f32_32x32x16_bf16 a[80:95], a[212:215], v[236:239], a[80:95]
    buffer_load_dwordx4 a[212:215], v7, s[92:95], s8 offen offset:1024 sc1
    v_exp_f32 v196, v132
    v_add_f32 v240, v240, v195
    v_mfma_f32_32x32x16_bf16 a[96:111], a[216:219], v[236:239], a[96:111]
    buffer_load_dwordx4 a[216:219], v7, s[92:95], s8 offen offset:2048 sc1
    v_exp_f32 v197, v133
    v_add_f32 v240, v240, v196
    v_mfma_f32_32x32x16_bf16 a[112:127], a[220:223], v[236:239], a[112:127]
    buffer_load_dwordx4 a[220:223], v7, s[92:95], s8 offen offset:3072 sc1
    v_exp_f32 v198, v134
    v_add_f32 v240, v240, v197
    v_mfma_f32_32x32x16_bf16 v[144:159], a[160:163], v[96:99], v[176:191]
    v_exp_f32 v199, v135
    v_exp_f32 v200, v136
    v_add_f32 v240, v240, v198
    v_mfma_f32_32x32x16_bf16 v[144:159], a[164:167], v[100:103], v[144:159]
    v_exp_f32 v201, v137
    v_add_f32 v240, v240, v199
    v_cvt_pk_bf16_f32 v224, v192, v193
    v_mfma_f32_32x32x16_bf16 v[144:159], a[168:171], v[104:107], v[144:159]
    v_exp_f32 v202, v138
    v_exp_f32 v203, v139
    v_add_f32 v240, v240, v200
    v_mfma_f32_32x32x16_bf16 v[144:159], a[172:175], v[108:111], v[144:159]
    v_exp_f32 v204, v140
    v_add_f32 v240, v240, v201
    v_cvt_pk_bf16_f32 v225, v194, v195
    v_add_f32 v240, v240, v202
    v_mfma_f32_32x32x16_bf16 v[144:159], a[176:179], v[112:115], v[144:159]
    v_exp_f32 v205, v141
    v_add_f32 v240, v240, v203
    v_cvt_pk_bf16_f32 v226, v196, v197
    v_mfma_f32_32x32x16_bf16 v[144:159], a[180:183], v[116:119], v[144:159]
    v_exp_f32 v206, v142
    v_add_f32 v240, v240, v204
    v_cvt_pk_bf16_f32 v227, v198, v199
    v_add_f32 v240, v240, v205
    v_mfma_f32_32x32x16_bf16 v[144:159], a[184:187], v[120:123], v[144:159]
    v_exp_f32 v207, v143
    v_add_f32 v240, v240, v206
    v_add_f32 v240, v240, v207
    v_cmp_lt_f32 vcc, s6, v240
    v_mfma_f32_32x32x16_bf16 v[144:159], a[188:191], v[124:127], v[144:159]
    s_cbranch_vccnz L_stub_25
L_ret_25:
    s_nop 0
    s_waitcnt vmcnt(16)
    s_add_u32 s7, s12, 0xc0000
    v_mfma_f32_32x32x16_bf16 a[0:15], a[224:227], v[224:227], a[0:15]
    buffer_load_dwordx4 a[160:163], v4, s[92:95], s7 offen offset:0 sc1
    v_cvt_pk_bf16_f32 v228, v200, v201
    v_cvt_pk_bf16_f32 v229, v202, v203
    v_mfma_f32_32x32x16_bf16 a[16:31], a[228:231], v[224:227], a[16:31]
    buffer_load_dwordx4 a[164:167], v4, s[92:95], s7 offen offset:1024 sc1
    v_cvt_pk_bf16_f32 v230, v204, v205
    v_cvt_pk_bf16_f32 v231, v206, v207
    v_add_f32 v242, v242, v240
    v_mfma_f32_32x32x16_bf16 a[32:47], a[232:235], v[224:227], a[32:47]
    buffer_load_dwordx4 a[168:171], v4, s[92:95], s7 offen offset:2048 sc1
    v_exp_f32 v192, v144
    v_exp_f32 v193, v145
    v_mfma_f32_32x32x16_bf16 a[48:63], a[236:239], v[224:227], a[48:63]
    buffer_load_dwordx4 a[172:175], v4, s[92:95], s7 offen offset:3072 sc1
    v_exp_f32 v194, v146
    v_add_f32 v241, v192, v193
    v_mfma_f32_32x32x16_bf16 a[0:15], a[240:243], v[228:231], a[0:15]
    buffer_load_dwordx4 a[176:179], v5, s[92:95], s7 offen offset:0 sc1
    v_exp_f32 v195, v147
    v_add_f32 v241, v241, v194
    v_mfma_f32_32x32x16_bf16 a[16:31], a[244:247], v[228:231], a[16:31]
    buffer_load_dwordx4 a[180:183], v5, s[92:95], s7 offen offset:1024 sc1
    v_exp_f32 v196, v148
    v_add_f32 v241, v241, v195
    v_mfma_f32_32x32x16_bf16 a[32:47], a[248:251], v[228:231], a[32:47]
    buffer_load_dwordx4 a[184:187], v5, s[92:95], s7 offen offset:2048 sc1
    v_exp_f32 v197, v149
    v_add_f32 v241, v241, v196
    v_mfma_f32_32x32x16_bf16 a[48:63], a[252:255], v[228:231], a[48:63]
    buffer_load_dwordx4 a[188:191], v5, s[92:95], s7 offen offset:3072 sc1
    v_exp_f32 v198, v150
    v_add_f32 v241, v241, v197
    s_waitcnt vmcnt(20)
    v_mfma_f32_32x32x16_bf16 v[128:143], a[128:131], v[64:67], v[160:175]
    v_exp_f32 v199, v151
    v_exp_f32 v200, v152
    v_add_f32 v241, v241, v198
    v_mfma_f32_32x32x16_bf16 v[128:143], a[132:135], v[68:71], v[128:143]
    v_exp_f32 v201, v153
    v_add_f32 v241, v241, v199
    v_cvt_pk_bf16_f32 v232, v192, v193
    v_mfma_f32_32x32x16_bf16 v[128:143], a[136:139], v[72:75], v[128:143]
    v_exp_f32 v202, v154
    v_exp_f32 v203, v155
    v_add_f32 v241, v241, v200
    v_mfma_f32_32x32x16_bf16 v[128:143], a[140:143], v[76:79], v[128:143]
    v_exp_f32 v204, v156
    v_add_f32 v241, v241, v201
    v_cvt_pk_bf16_f32 v233, v194, v195
    v_add_f32 v241, v241, v202
    s_waitcnt vmcnt(16)
    v_mfma_f32_32x32x16_bf16 v[128:143], a[144:147], v[80:83], v[128:143]
    v_exp_f32 v205, v157
    v_add_f32 v241, v241, v203
    v_cvt_pk_bf16_f32 v234, v196, v197
    v_mfma_f32_32x32x16_bf16 v[128:143], a[148:151], v[84:87], v[128:143]
    v_exp_f32 v206, v158
    v_add_f32 v241, v241, v204
    v_cvt_pk_bf16_f32 v235, v198, v199
    v_add_f32 v241, v241, v205
    v_mfma_f32_32x32x16_bf16 v[128:143], a[152:155], v[88:91], v[128:143]
    v_exp_f32 v207, v159
    v_add_f32 v241, v241, v206
    v_add_f32 v241, v241, v207
    v_cmp_lt_f32 vcc, s6, v241
    v_mfma_f32_32x32x16_bf16 v[128:143], a[156:159], v[92:95], v[128:143]
    s_cbranch_vccnz L_stub_26
L_ret_26:
    s_nop 0
    s_add_u32 s8, s12, 0xc0000
    v_mfma_f32_32x32x16_bf16 a[64:79], a[224:227], v[232:235], a[64:79]
    buffer_load_dwordx4 a[224:227], v6, s[92:95], s8 offen offset:0 sc1
    v_cvt_pk_bf16_f32 v236, v200, v201
    v_cvt_pk_bf16_f32 v237, v202, v203
    v_mfma_f32_32x32x16_bf16 a[80:95], a[228:231], v[232:235], a[80:95]
    buffer_load_dwordx4 a[228:231], v6, s[92:95], s8 offen offset:1024 sc1
    v_cvt_pk_bf16_f32 v238, v204, v205
    v_cvt_pk_bf16_f32 v239, v206, v207
    v_add_f32 v243, v243, v241
    v_mfma_f32_32x32x16_bf16 a[96:111], a[232:235], v[232:235], a[96:111]
    buffer_load_dwordx4 a[232:235], v6, s[92:95], s8 offen offset:2048 sc1
    v_exp_f32 v192, v128
    v_exp_f32 v193, v129
    v_mfma_f32_32x32x16_bf16 a[112:127], a[236:239], v[232:235], a[112:127]
    buffer_load_dwordx4 a[236:239], v6, s[92:95], s8 offen offset:3072 sc1
    v_exp_f32 v194, v130
    v_add_f32 v240, v192, v193
    v_mfma_f32_32x32x16_bf16 a[64:79], a[240:243], v[236:239], a[64:79]
    buffer_load_dwordx4 a[240:243], v7, s[92:95], s8 offen offset:0 sc1
    v_exp_f32 v195, v131
    v_add_f32 v240, v240, v194
    v_mfma_f32_32x32x16_bf16 a[80:95], a[244:247], v[236:239], a[80:95]
    buffer_load_dwordx4 a[244:247], v7, s[92:95], s8 offen offset:1024 sc1
    v_exp_f32 v196, v132
    v_add_f32 v240, v240, v195
    v_mfma_f32_32x32x16_bf16 a[96:111], a[248:251], v[236:239], a[96:111]
    buffer_load_dwordx4 a[248:251], v7, s[92:95], s8 offen offset:2048 sc1
    v_exp_f32 v197, v133
    v_add_f32 v240, v240, v196
    v_mfma_f32_32x32x16_bf16 a[112:127], a[252:255], v[236:239], a[112:127]
    buffer_load_dwordx4 a[252:255], v7, s[92:95], s8 offen offset:3072 sc1
    v_exp_f32 v198, v134
    v_add_f32 v240, v240, v197
    v_mfma_f32_32x32x16_bf16 v[144:159], a[128:131], v[96:99], v[176:191]
    v_exp_f32 v199, v135
    v_exp_f32 v200, v136
    v_add_f32 v240, v240, v198
    v_mfma_f32_32x32x16_bf16 v[144:159], a[132:135], v[100:103], v[144:159]
    v_exp_f32 v201, v137
    v_add_f32 v240, v240, v199
    v_cvt_pk_bf16_f32 v224, v192, v193
    v_mfma_f32_32x32x16_bf16 v[144:159], a[136:139], v[104:107], v[144:159]
    v_exp_f32 v202, v138
    v_exp_f32 v203, v139
    v_add_f32 v240, v240, v200
    v_mfma_f32_32x32x16_bf16 v[144:159], a[140:143], v[108:111], v[144:159]
    v_exp_f32 v204, v140
    v_add_f32 v240, v240, v201
    v_cvt_pk_bf16_f32 v225, v194, v195
    v_add_f32 v240, v240, v202
    v_mfma_f32_32x32x16_bf16 v[144:159], a[144:147], v[112:115], v[144:159]
    v_exp_f32 v205, v141
    v_add_f32 v240, v240, v203
    v_cvt_pk_bf16_f32 v226, v196, v197
    v_mfma_f32_32x32x16_bf16 v[144:159], a[148:151], v[116:119], v[144:159]
    v_exp_f32 v206, v142
    v_add_f32 v240, v240, v204
    v_cvt_pk_bf16_f32 v227, v198, v199
    v_add_f32 v240, v240, v205
    v_mfma_f32_32x32x16_bf16 v[144:159], a[152:155], v[120:123], v[144:159]
    v_exp_f32 v207, v143
    v_add_f32 v240, v240, v206
    v_add_f32 v240, v240, v207
    v_cmp_lt_f32 vcc, s6, v240
    v_mfma_f32_32x32x16_bf16 v[144:159], a[156:159], v[124:127], v[144:159]
    s_cbranch_vccnz L_stub_27
L_ret_27:
    s_nop 0
    s_waitcnt vmcnt(16)
    v_mfma_f32_32x32x16_bf16 a[0:15], a[192:195], v[224:227], a[0:15]
    s_nop 0
    v_cvt_pk_bf16_f32 v228, v200, v201
    v_cvt_pk_bf16_f32 v229, v202, v203
    v_mfma_f32_32x32x16_bf16 a[16:31], a[196:199], v[224:227], a[16:31]
    s_nop 0
    v_cvt_pk_bf16_f32 v230, v204, v205
    v_cvt_pk_bf16_f32 v231, v206, v207
    v_add_f32 v242, v242, v240
    v_mfma_f32_32x32x16_bf16 a[32:47], a[200:203], v[224:227], a[32:47]
    s_nop 0
    v_exp_f32 v192, v144
    v_exp_f32 v193, v145
    v_mfma_f32_32x32x16_bf16 a[48:63], a[204:207], v[224:227], a[48:63]
    v_exp_f32 v194, v146
    v_add_f32 v241, v192, v193
    v_mfma_f32_32x32x16_bf16 a[0:15], a[208:211], v[228:231], a[0:15]
    v_exp_f32 v195, v147
    v_add_f32 v241, v241, v194
    v_mfma_f32_32x32x16_bf16 a[16:31], a[212:215], v[228:231], a[16:31]
    v_exp_f32 v196, v148
    v_add_f32 v241, v241, v195
    v_mfma_f32_32x32x16_bf16 a[32:47], a[216:219], v[228:231], a[32:47]
    v_exp_f32 v197, v149
    v_add_f32 v241, v241, v196
    v_mfma_f32_32x32x16_bf16 a[48:63], a[220:223], v[228:231], a[48:63]
    v_exp_f32 v198, v150
    v_add_f32 v241, v241, v197
    s_waitcnt vmcnt(12)
    v_mfma_f32_32x32x16_bf16 v[128:143], a[160:163], v[64:67], v[160:175]
    v_exp_f32 v199, v151
    v_exp_f32 v200, v152
    v_add_f32 v241, v241, v198
    v_mfma_f32_32x32x16_bf16 v[128:143], a[164:167], v[68:71], v[128:143]
    v_exp_f32 v201, v153
    v_add_f32 v241, v241, v199
    v_cvt_pk_bf16_f32 v232, v192, v193
    v_mfma_f32_32x32x16_bf16 v[128:143], a[168:171], v[72:75], v[128:143]
    v_exp_f32 v202, v154
    v_exp_f32 v203, v155
    v_add_f32 v241, v241, v200
    v_mfma_f32_32x32x16_bf16 v[128:143], a[172:175], v[76:79], v[128:143]
    v_exp_f32 v204, v156
    v_add_f32 v241, v241, v201
    v_cvt_pk_bf16_f32 v233, v194, v195
    v_add_f32 v241, v241, v202
    s_waitcnt vmcnt(8)
    v_mfma_f32_32x32x16_bf16 v[128:143], a[176:179], v[80:83], v[128:143]
    v_exp_f32 v205, v157
    v_add_f32 v241, v241, v203
    v_cvt_pk_bf16_f32 v234, v196, v197
    v_mfma_f32_32x32x16_bf16 v[128:143], a[180:183], v[84:87], v[128:143]
    v_exp_f32 v206, v158
    v_add_f32 v241, v241, v204
    v_cvt_pk_bf16_f32 v235, v198, v199
    v_add_f32 v241, v241, v205
    v_mfma_f32_32x32x16_bf16 v[128:143], a[184:187], v[88:91], v[128:143]
    v_exp_f32 v207, v159
    v_add_f32 v241, v241, v206
    v_add_f32 v241, v241, v207
    v_cmp_lt_f32 vcc, s6, v241
    v_mfma_f32_32x32x16_bf16 v[128:143], a[188:191], v[92:95], v[128:143]
    s_cbranch_vccnz L_stub_28
L_ret_28:
    s_nop 0
    v_mfma_f32_32x32x16_bf16 a[64:79], a[192:195], v[232:235], a[64:79]
    s_nop 0
    v_cvt_pk_bf16_f32 v236, v200, v201
    v_cvt_pk_bf16_f32 v237, v202, v203
    v_mfma_f32_32x32x16_bf16 a[80:95], a[196:199], v[232:235], a[80:95]
    s_nop 0
    v_cvt_pk_bf16_f32 v238, v204, v205
    v_cvt_pk_bf16_f32 v239, v206, v207
    v_add_f32 v243, v243, v241
    v_mfma_f32_32x32x16_bf16 a[96:111], a[200:203], v[232:235], a[96:111]
    s_nop 0
    v_exp_f32 v192, v128
    v_exp_f32 v193, v129
    v_mfma_f32_32x32x16_bf16 a[112:127], a[204:207], v[232:235], a[112:127]
    v_exp_f32 v194, v130
    v_add_f32 v240, v192, v193
    v_mfma_f32_32x32x16_bf16 a[64:79], a[208:211], v[236:239], a[64:79]
    v_exp_f32 v195, v131
    v_add_f32 v240, v240, v194
    v_mfma_f32_32x32x16_bf16 a[80:95], a[212:215], v[236:239], a[80:95]
    v_exp_f32 v196, v132
    v_add_f32 v240, v240, v195
    v_mfma_f32_32x32x16_bf16 a[96:111], a[216:219], v[236:239], a[96:111]
    v_exp_f32 v197, v133
    v_add_f32 v240, v240, v196
    v_mfma_f32_32x32x16_bf16 a[112:127], a[220:223], v[236:239], a[112:127]
    v_exp_f32 v198, v134
    v_add_f32 v240, v240, v197
    v_mfma_f32_32x32x16_bf16 v[144:159], a[160:163], v[96:99], v[176:191]
    v_exp_f32 v199, v135
    v_exp_f32 v200, v136
    v_add_f32 v240, v240, v198
    v_mfma_f32_32x32x16_bf16 v[144:159], a[164:167], v[100:103], v[144:159]
    v_exp_f32 v201, v137
    v_add_f32 v240, v240, v199
    v_cvt_pk_bf16_f32 v224, v192, v193
    v_mfma_f32_32x32x16_bf16 v[144:159], a[168:171], v[104:107], v[144:159]
    v_exp_f32 v202, v138
    v_exp_f32 v203, v139
    v_add_f32 v240, v240, v200
    v_mfma_f32_32x32x16_bf16 v[144:159], a[172:175], v[108:111], v[144:159]
    v_exp_f32 v204, v140
    v_add_f32 v240, v240, v201
    v_cvt_pk_bf16_f32 v225, v194, v195
    v_add_f32 v240, v240, v202
    v_mfma_f32_32x32x16_bf16 v[144:159], a[176:179], v[112:115], v[144:159]
    v_exp_f32 v205, v141
    v_add_f32 v240, v240, v203
    v_cvt_pk_bf16_f32 v226, v196, v197
    v_mfma_f32_32x32x16_bf16 v[144:159], a[180:183], v[116:119], v[144:159]
    v_exp_f32 v206, v142
    v_add_f32 v240, v240, v204
    v_cvt_pk_bf16_f32 v227, v198, v199
    v_add_f32 v240, v240, v205
    v_mfma_f32_32x32x16_bf16 v[144:159], a[184:187], v[120:123], v[144:159]
    v_exp_f32 v207, v143
    v_add_f32 v240, v240, v206
    v_add_f32 v240, v240, v207
    v_cmp_lt_f32 vcc, s6, v240
    v_mfma_f32_32x32x16_bf16 v[144:159], a[188:191], v[124:127], v[144:159]
    s_cbranch_vccnz L_stub_29
L_ret_29:
    s_nop 0
    s_waitcnt vmcnt(0)
    v_mfma_f32_32x32x16_bf16 a[0:15], a[224:227], v[224:227], a[0:15]
    s_nop 0
    v_cvt_pk_bf16_f32 v228, v200, v201
    v_cvt_pk_bf16_f32 v229, v202, v203
    v_mfma_f32_32x32x16_bf16 a[16:31], a[228:231], v[224:227], a[16:31]
    s_nop 0
    v_cvt_pk_bf16_f32 v230, v204, v205
    v_cvt_pk_bf16_f32 v231, v206, v207
    v_add_f32 v242, v242, v240
    v_mfma_f32_32x32x16_bf16 a[32:47], a[232:235], v[224:227], a[32:47]
    s_nop 0
    v_exp_f32 v192, v144
    v_exp_f32 v193, v145
    v_mfma_f32_32x32x16_bf16 a[48:63], a[236:239], v[224:227], a[48:63]
    v_exp_f32 v194, v146
    v_add_f32 v241, v192, v193
    v_mfma_f32_32x32x16_bf16 a[0:15], a[240:243], v[228:231], a[0:15]
    v_exp_f32 v195, v147
    v_add_f32 v241, v241, v194
    v_mfma_f32_32x32x16_bf16 a[16:31], a[244:247], v[228:231], a[16:31]
    v_exp_f32 v196, v148
    v_add_f32 v241, v241, v195
    v_mfma_f32_32x32x16_bf16 a[32:47], a[248:251], v[228:231], a[32:47]
    v_exp_f32 v197, v149
    v_add_f32 v241, v241, v196
    v_mfma_f32_32x32x16_bf16 a[48:63], a[252:255], v[228:231], a[48:63]
    v_exp_f32 v198, v150
    v_add_f32 v241, v241, v197
    s_cmp_eq_u32 s3, 1
    s_cbranch_scc1 L_tail_1
    s_cmp_eq_u32 s3, 2
    s_cbranch_scc1 L_tail_2
    s_cmp_eq_u32 s3, 3
    s_cbranch_scc1 L_tail_3
L_tail_0:
    v_add_u32 v8, 0x0, v4
    v_add_u32 v9, 0x10000, v4
    v_and_b32 v11, 31, v2
    v_lshlrev_b32 v12, 8, v11
    v_lshlrev_b32 v11, 5, v11
    v_add_u32 v11, 0x18000, v11
    v_add_u32 v10, 0, v11
    v_lshrrev_b32 v13, 5, v2
    v_lshl_add_u32 v12, v13, 4, v12
    s_lshl_b32 s101, s4, 19
    s_lshl_b32 s97, s5, 14
    s_add_u32 s101, s101, s97
    s_add_u32 s101, s101, 0
    v_add_u32 v12, s101, v12
    s_mov_b32 s97, 0x2000
    v_exp_f32 v199, v151
    ds_write_b128 v8, a[16:19] offset:0
    v_exp_f32 v200, v152
    ds_write_b128 v8, a[20:23] offset:1024
    v_add_f32 v241, v241, v198
    ds_write_b128 v8, a[24:27] offset:2048
    v_exp_f32 v201, v153
    ds_write_b128 v8, a[28:31] offset:3072
    v_add_f32 v241, v241, v199
    ds_write_b128 v8, a[32:35] offset:8192
    v_cvt_pk_bf16_f32 v232, v192, v193
    ds_write_b128 v8, a[36:39] offset:9216
    v_exp_f32 v202, v154
    ds_write_b128 v8, a[40:43] offset:10240
    v_exp_f32 v203, v155
    ds_write_b128 v8, a[44:47] offset:11264
    v_add_f32 v241, v241, v200
    ds_write_b128 v8, a[48:51] offset:16384
    v_exp_f32 v204, v156
    ds_write_b128 v8, a[52:55] offset:17408
    v_add_f32 v241, v241, v201
    ds_write_b128 v8, a[56:59] offset:18432
    v_cvt_pk_bf16_f32 v233, v194, v195
    ds_write_b128 v8, a[60:63] offset:19456
    v_add_f32 v241, v241, v202
    v_exp_f32 v205, v157
    v_add_f32 v241, v241, v203
    v_cvt_pk_bf16_f32 v234, v196, v197
    v_exp_f32 v206, v158
    v_add_f32 v241, v241, v204
    v_cvt_pk_bf16_f32 v235, v198, v199
    v_add_f32 v241, v241, v205
    v_exp_f32 v207, v159
    v_add_f32 v241, v241, v206
    v_add_f32 v241, v241, v207
    v_cmp_lt_f32 vcc, s6, v241
    s_nop 0
    s_cbranch_vccnz L_stub_30
L_ret_30:
    v_mfma_f32_32x32x16_bf16 a[64:79], a[224:227], v[232:235], a[64:79]
    s_nop 0
    v_cvt_pk_bf16_f32 v236, v200, v201
    v_cvt_pk_bf16_f32 v237, v202, v203
    v_mfma_f32_32x32x16_bf16 a[80:95], a[228:231], v[232:235], a[80:95]
    s_nop 0
    v_cvt_pk_bf16_f32 v238, v204, v205
    v_cvt_pk_bf16_f32 v239, v206, v207
    v_add_f32 v243, v243, v241
    v_mfma_f32_32x32x16_bf16 a[96:111], a[232:235], v[232:235], a[96:111]
    v_mov_b32 v247, v242
    v_mov_b32 v246, v244
    s_nop 0
    v_permlane32_swap_b32 v242, v247
    s_nop 0
    v_mfma_f32_32x32x16_bf16 a[112:127], a[236:239], v[232:235], a[112:127]
    s_nop 1
    v_add_f32 v247, v242, v247
    ds_write_b64 v10, v[246:247] offset:0
    v_accvgpr_read_b32 v16, a0
    v_mfma_f32_32x32x16_bf16 a[64:79], a[240:243], v[236:239], a[64:79]
    v_accvgpr_read_b32 v17, a1
    v_accvgpr_read_b32 v18, a2
    v_accvgpr_read_b32 v19, a3
    v_accvgpr_read_b32 v20, a4
    v_mfma_f32_32x32x16_bf16 a[80:95], a[244:247], v[236:239], a[80:95]
    v_accvgpr_read_b32 v21, a5
    v_accvgpr_read_b32 v22, a6
    v_accvgpr_read_b32 v23, a7
    v_accvgpr_read_b32 v24, a8
    v_mfma_f32_32x32x16_bf16 a[96:111], a[248:251], v[236:239], a[96:111]
    v_accvgpr_read_b32 v25, a9
    v_accvgpr_read_b32 v26, a10
    v_accvgpr_read_b32 v27, a11
    v_accvgpr_read_b32 v28, a12
    v_mfma_f32_32x32x16_bf16 a[112:127], a[252:255], v[236:239], a[112:127]
    v_accvgpr_read_b32 v29, a13
    v_accvgpr_read_b32 v30, a14
    v_accvgpr_read_b32 v31, a15
    s_waitcnt lgkmcnt(0)
    s_barrier
    ds_read_b128 v[48:51], v11 offset:0
    ds_read_b128 v[52:55], v11 offset:16
    ds_read_b128 v[64:67], v4 offset:40960
    ds_read_b128 v[68:71], v4 offset:41984
    ds_read_b128 v[72:75], v4 offset:43008
    ds_read_b128 v[76:79], v4 offset:44032
    ds_read_b128 v[80:83], v4 offset:57344
    ds_read_b128 v[84:87], v4 offset:58368
    ds_read_b128 v[88:91], v4 offset:59392
    ds_read_b128 v[92:95], v4 offset:60416
    ds_read_b128 v[96:99], v9 offset:8192
    ds_read_b128 v[100:103], v9 offset:9216
    ds_read_b128 v[104:107], v9 offset:10240
    ds_read_b128 v[108:111], v9 offset:11264
    ds_write_b128 v8, a[80:83] offset:4096
    ds_write_b128 v8, a[84:87] offset:5120
    ds_write_b128 v8, a[88:91] offset:6144
    ds_write_b128 v8, a[92:95] offset:7168
    ds_write_b128 v8, a[96:99] offset:12288
    ds_write_b128 v8, a[100:103] offset:13312
    ds_write_b128 v8, a[104:107] offset:14336
    ds_write_b128 v8, a[108:111] offset:15360
    ds_write_b128 v8, a[112:115] offset:20480
    ds_write_b128 v8, a[116:119] offset:21504
    ds_write_b128 v8, a[120:123] offset:22528
    ds_write_b128 v8, a[124:127] offset:23552
    v_mov_b32 v249, v243
    v_mov_b32 v248, v245
    s_nop 0
    v_permlane32_swap_b32 v243, v249
    s_nop 1
    v_add_f32 v249, v243, v249
    ds_write_b64 v10, v[248:249] offset:1024
    s_waitcnt lgkmcnt(15)
    v_max3_f32 v250, v48, v50, v52
    v_max_f32 v250, v250, v54
    v_sub_f32 v48, v48, v250
    v_sub_f32 v50, v50, v250
    v_sub_f32 v52, v52, v250
    v_sub_f32 v54, v54, v250
    v_exp_f32 v48, v48
    v_exp_f32 v50, v50
    v_exp_f32 v52, v52
    v_exp_f32 v54, v54
    s_nop 0
    v_mul_f32 v251, v48, v49
    v_fmac_f32 v251, v50, v51
    v_fmac_f32 v251, v52, v53
    v_fmac_f32 v251, v54, v55
    v_rcp_f32 v251, v251
    s_nop 0
    v_mul_f32 v48, v48, v251
    v_mul_f32 v50, v50, v251
    v_mul_f32 v52, v52, v251
    v_mul_f32 v54, v54, v251
    v_pk_mul_f32 v[16:17], v[16:17], v[48:49] op_sel_hi:[1,0]
    v_pk_mul_f32 v[18:19], v[18:19], v[48:49] op_sel_hi:[1,0]
    v_pk_mul_f32 v[20:21], v[20:21], v[48:49] op_sel_hi:[1,0]
    v_pk_mul_f32 v[22:23], v[22:23], v[48:49] op_sel_hi:[1,0]
    v_pk_mul_f32 v[24:25], v[24:25], v[48:49] op_sel_hi:[1,0]
    v_pk_mul_f32 v[26:27], v[26:27], v[48:49] op_sel_hi:[1,0]
    v_pk_mul_f32 v[28:29], v[28:29], v[48:49] op_sel_hi:[1,0]
    v_pk_mul_f32 v[30:31], v[30:31], v[48:49] op_sel_hi:[1,0]
    s_waitcnt lgkmcnt(15)
    v_pk_fma_f32 v[16:17], v[64:65], v[50:51], v[16:17] op_sel_hi:[1,0,1]
    v_pk_fma_f32 v[18:19], v[66:67], v[50:51], v[18:19] op_sel_hi:[1,0,1]
    v_pk_fma_f32 v[20:21], v[68:69], v[50:51], v[20:21] op_sel_hi:[1,0,1]
    v_pk_fma_f32 v[22:23], v[70:71], v[50:51], v[22:23] op_sel_hi:[1,0,1]
    v_pk_fma_f32 v[24:25], v[72:73], v[50:51], v[24:25] op_sel_hi:[1,0,1]
    v_pk_fma_f32 v[26:27], v[74:75], v[50:51], v[26:27] op_sel_hi:[1,0,1]
    v_pk_fma_f32 v[28:29], v[76:77], v[50:51], v[28:29] op_sel_hi:[1,0,1]
    v_pk_fma_f32 v[30:31], v[78:79], v[50:51], v[30:31] op_sel_hi:[1,0,1]
    s_waitcnt lgkmcnt(15)
    v_pk_fma_f32 v[16:17], v[80:81], v[52:53], v[16:17] op_sel_hi:[1,0,1]
    v_pk_fma_f32 v[18:19], v[82:83], v[52:53], v[18:19] op_sel_hi:[1,0,1]
    v_pk_fma_f32 v[20:21], v[84:85], v[52:53], v[20:21] op_sel_hi:[1,0,1]
    v_pk_fma_f32 v[22:23], v[86:87], v[52:53], v[22:23] op_sel_hi:[1,0,1]
    v_pk_fma_f32 v[24:25], v[88:89], v[52:53], v[24:25] op_sel_hi:[1,0,1]
    v_pk_fma_f32 v[26:27], v[90:91], v[52:53], v[26:27] op_sel_hi:[1,0,1]
    v_pk_fma_f32 v[28:29], v[92:93], v[52:53], v[28:29] op_sel_hi:[1,0,1]
    v_pk_fma_f32 v[30:31], v[94:95], v[52:53], v[30:31] op_sel_hi:[1,0,1]
    s_waitcnt lgkmcnt(13)
    v_pk_fma_f32 v[16:17], v[96:97], v[54:55], v[16:17] op_sel_hi:[1,0,1]
    v_pk_fma_f32 v[18:19], v[98:99], v[54:55], v[18:19] op_sel_hi:[1,0,1]
    v_pk_fma_f32 v[20:21], v[100:101], v[54:55], v[20:21] op_sel_hi:[1,0,1]
    v_pk_fma_f32 v[22:23], v[102:103], v[54:55], v[22:23] op_sel_hi:[1,0,1]
    v_pk_fma_f32 v[24:25], v[104:105], v[54:55], v[24:25] op_sel_hi:[1,0,1]
    v_pk_fma_f32 v[26:27], v[106:107], v[54:55], v[26:27] op_sel_hi:[1,0,1]
    v_pk_fma_f32 v[28:29], v[108:109], v[54:55], v[28:29] op_sel_hi:[1,0,1]
    v_pk_fma_f32 v[30:31], v[110:111], v[54:55], v[30:31] op_sel_hi:[1,0,1]
    v_cvt_pk_bf16_f32 v224, v16, v17
    v_cvt_pk_bf16_f32 v225, v18, v19
    v_cvt_pk_bf16_f32 v226, v20, v21
    v_cvt_pk_bf16_f32 v227, v22, v23
    v_cvt_pk_bf16_f32 v228, v24, v25
    v_cvt_pk_bf16_f32 v229, v26, v27
    v_cvt_pk_bf16_f32 v230, v28, v29
    v_cvt_pk_bf16_f32 v231, v30, v31
    s_nop 1
    v_permlane32_swap_b32 v224, v226
    v_permlane32_swap_b32 v225, v227
    v_permlane32_swap_b32 v228, v230
    v_permlane32_swap_b32 v229, v231
    buffer_store_dwordx4 v[224:227], v12, s[88:91], 0 offen
    buffer_store_dwordx4 v[228:231], v12, s[88:91], 0 offen offset:32
    v_accvgpr_read_b32 v32, a64
    v_accvgpr_read_b32 v33, a65
    v_accvgpr_read_b32 v34, a66
    v_accvgpr_read_b32 v35, a67
    v_accvgpr_read_b32 v36, a68
    v_accvgpr_read_b32 v37, a69
    v_accvgpr_read_b32 v38, a70
    v_accvgpr_read_b32 v39, a71
    v_accvgpr_read_b32 v40, a72
    v_accvgpr_read_b32 v41, a73
    v_accvgpr_read_b32 v42, a74
    v_accvgpr_read_b32 v43, a75
    v_accvgpr_read_b32 v44, a76
    v_accvgpr_read_b32 v45, a77
    v_accvgpr_read_b32 v46, a78
    v_accvgpr_read_b32 v47, a79
    s_waitcnt lgkmcnt(0)
    s_barrier
    ds_read_b128 v[56:59], v11 offset:1024
    ds_read_b128 v[60:63], v11 offset:1040
    ds_read_b128 v[112:115], v4 offset:45056
    ds_read_b128 v[116:119], v4 offset:46080
    ds_read_b128 v[120:123], v4 offset:47104
    ds_read_b128 v[124:127], v4 offset:48128
    ds_read_b128 v[128:131], v4 offset:61440
    ds_read_b128 v[132:135], v4 offset:62464
    ds_read_b128 v[136:139], v4 offset:63488
    ds_read_b128 v[140:143], v4 offset:64512
    ds_read_b128 v[144:147], v9 offset:12288
    ds_read_b128 v[148:151], v9 offset:13312
    ds_read_b128 v[152:155], v9 offset:14336
    ds_read_b128 v[156:159], v9 offset:15360
    s_waitcnt lgkmcnt(12)
    v_max3_f32 v250, v56, v58, v60
    v_max_f32 v250, v250, v62
    v_sub_f32 v56, v56, v250
    v_sub_f32 v58, v58, v250
    v_sub_f32 v60, v60, v250
    v_sub_f32 v62, v62, v250
    v_exp_f32 v56, v56
    v_exp_f32 v58, v58
    v_exp_f32 v60, v60
    v_exp_f32 v62, v62
    s_nop 0
    v_mul_f32 v251, v56, v57
    v_fmac_f32 v251, v58, v59
    v_fmac_f32 v251, v60, v61
    v_fmac_f32 v251, v62, v63
    v_rcp_f32 v251, v251
    s_nop 0
    v_mul_f32 v56, v56, v251
    v_mul_f32 v58, v58, v251
    v_mul_f32 v60, v60, v251
    v_mul_f32 v62, v62, v251
    v_pk_mul_f32 v[32:33], v[32:33], v[56:57] op_sel_hi:[1,0]
    v_pk_mul_f32 v[34:35], v[34:35], v[56:57] op_sel_hi:[1,0]
    v_pk_mul_f32 v[36:37], v[36:37], v[56:57] op_sel_hi:[1,0]
    v_pk_mul_f32 v[38:39], v[38:39], v[56:57] op_sel_hi:[1,0]
    v_pk_mul_f32 v[40:41], v[40:41], v[56:57] op_sel_hi:[1,0]
    v_pk_mul_f32 v[42:43], v[42:43], v[56:57] op_sel_hi:[1,0]
    v_pk_mul_f32 v[44:45], v[44:45], v[56:57] op_sel_hi:[1,0]
    v_pk_mul_f32 v[46:47], v[46:47], v[56:57] op_sel_hi:[1,0]
    s_waitcnt lgkmcnt(8)
    v_pk_fma_f32 v[32:33], v[112:113], v[58:59], v[32:33] op_sel_hi:[1,0,1]
    v_pk_fma_f32 v[34:35], v[114:115], v[58:59], v[34:35] op_sel_hi:[1,0,1]
    v_pk_fma_f32 v[36:37], v[116:117], v[58:59], v[36:37] op_sel_hi:[1,0,1]
    v_pk_fma_f32 v[38:39], v[118:119], v[58:59], v[38:39] op_sel_hi:[1,0,1]
    v_pk_fma_f32 v[40:41], v[120:121], v[58:59], v[40:41] op_sel_hi:[1,0,1]
    v_pk_fma_f32 v[42:43], v[122:123], v[58:59], v[42:43] op_sel_hi:[1,0,1]
    v_pk_fma_f32 v[44:45], v[124:125], v[58:59], v[44:45] op_sel_hi:[1,0,1]
    v_pk_fma_f32 v[46:47], v[126:127], v[58:59], v[46:47] op_sel_hi:[1,0,1]
    s_waitcnt lgkmcnt(4)
    v_pk_fma_f32 v[32:33], v[128:129], v[60:61], v[32:33] op_sel_hi:[1,0,1]
    v_pk_fma_f32 v[34:35], v[130:131], v[60:61], v[34:35] op_sel_hi:[1,0,1]
    v_pk_fma_f32 v[36:37], v[132:133], v[60:61], v[36:37] op_sel_hi:[1,0,1]
    v_pk_fma_f32 v[38:39], v[134:135], v[60:61], v[38:39] op_sel_hi:[1,0,1]
    v_pk_fma_f32 v[40:41], v[136:137], v[60:61], v[40:41] op_sel_hi:[1,0,1]
    v_pk_fma_f32 v[42:43], v[138:139], v[60:61], v[42:43] op_sel_hi:[1,0,1]
    v_pk_fma_f32 v[44:45], v[140:141], v[60:61], v[44:45] op_sel_hi:[1,0,1]
    v_pk_fma_f32 v[46:47], v[142:143], v[60:61], v[46:47] op_sel_hi:[1,0,1]
    s_waitcnt lgkmcnt(0)
    v_pk_fma_f32 v[32:33], v[144:145], v[62:63], v[32:33] op_sel_hi:[1,0,1]
    v_pk_fma_f32 v[34:35], v[146:147], v[62:63], v[34:35] op_sel_hi:[1,0,1]
    v_pk_fma_f32 v[36:37], v[148:149], v[62:63], v[36:37] op_sel_hi:[1,0,1]
    v_pk_fma_f32 v[38:39], v[150:151], v[62:63], v[38:39] op_sel_hi:[1,0,1]
    v_pk_fma_f32 v[40:41], v[152:153], v[62:63], v[40:41] op_sel_hi:[1,0,1]
    v_pk_fma_f32 v[42:43], v[154:155], v[62:63], v[42:43] op_sel_hi:[1,0,1]
    v_pk_fma_f32 v[44:45], v[156:157], v[62:63], v[44:45] op_sel_hi:[1,0,1]
    v_pk_fma_f32 v[46:47], v[158:159], v[62:63], v[46:47] op_sel_hi:[1,0,1]
    v_cvt_pk_bf16_f32 v232, v32, v33
    v_cvt_pk_bf16_f32 v233, v34, v35
    v_cvt_pk_bf16_f32 v234, v36, v37
    v_cvt_pk_bf16_f32 v235, v38, v39
    v_cvt_pk_bf16_f32 v236, v40, v41
    v_cvt_pk_bf16_f32 v237, v42, v43
    v_cvt_pk_bf16_f32 v238, v44, v45
    v_cvt_pk_bf16_f32 v239, v46, v47
    s_nop 1
    v_permlane32_swap_b32 v232, v234
    v_permlane32_swap_b32 v233, v235
    v_permlane32_swap_b32 v236, v238
    v_permlane32_swap_b32 v237, v239
    buffer_store_dwordx4 v[232:235], v12, s[88:91], s97 offen
    buffer_store_dwordx4 v[236:239], v12, s[88:91], s97 offen offset:32
    s_endpgm
L_tail_1:
    v_add_u32 v8, 0x6000, v4
    v_add_u32 v9, 0x10000, v4
    v_and_b32 v11, 31, v2
    v_lshlrev_b32 v12, 8, v11
    v_lshlrev_b32 v11, 5, v11
    v_add_u32 v11, 0x18000, v11
    v_add_u32 v10, 8, v11
    v_lshrrev_b32 v13, 5, v2
    v_lshl_add_u32 v12, v13, 4, v12
    s_lshl_b32 s101, s4, 19
    s_lshl_b32 s97, s5, 14
    s_add_u32 s101, s101, s97
    s_add_u32 s101, s101, 64
    v_add_u32 v12, s101, v12
    s_mov_b32 s97, 0x2000
    v_exp_f32 v199, v151
    ds_write_b128 v8, a[32:35] offset:0
    v_exp_f32 v200, v152
    ds_write_b128 v8, a[36:39] offset:1024
    v_add_f32 v241, v241, v198
    ds_write_b128 v8, a[40:43] offset:2048
    v_exp_f32 v201, v153
    ds_write_b128 v8, a[44:47] offset:3072
    v_add_f32 v241, v241, v199
    ds_write_b128 v8, a[48:51] offset:8192
    v_cvt_pk_bf16_f32 v232, v192, v193
    ds_write_b128 v8, a[52:55] offset:9216
    v_exp_f32 v202, v154
    ds_write_b128 v8, a[56:59] offset:10240
    v_exp_f32 v203, v155
    ds_write_b128 v8, a[60:63] offset:11264
    v_add_f32 v241, v241, v200
    ds_write_b128 v8, a[0:3] offset:16384
    v_exp_f32 v204, v156
    ds_write_b128 v8, a[4:7] offset:17408
    v_add_f32 v241, v241, v201
    ds_write_b128 v8, a[8:11] offset:18432
    v_cvt_pk_bf16_f32 v233, v194, v195
    ds_write_b128 v8, a[12:15] offset:19456
    v_add_f32 v241, v241, v202
    v_exp_f32 v205, v157
    v_add_f32 v241, v241, v203
    v_cvt_pk_bf16_f32 v234, v196, v197
    v_exp_f32 v206, v158
    v_add_f32 v241, v241, v204
    v_cvt_pk_bf16_f32 v235, v198, v199
    v_add_f32 v241, v241, v205
    v_exp_f32 v207, v159
    v_add_f32 v241, v241, v206
    v_add_f32 v241, v241, v207
    v_cmp_lt_f32 vcc, s6, v241
    s_nop 0
    s_cbranch_vccnz L_stub_31
L_ret_31:
    v_mfma_f32_32x32x16_bf16 a[64:79], a[224:227], v[232:235], a[64:79]
    s_nop 0
    v_cvt_pk_bf16_f32 v236, v200, v201
    v_cvt_pk_bf16_f32 v237, v202, v203
    v_mfma_f32_32x32x16_bf16 a[80:95], a[228:231], v[232:235], a[80:95]
    s_nop 0
    v_cvt_pk_bf16_f32 v238, v204, v205
    v_cvt_pk_bf16_f32 v239, v206, v207
    v_add_f32 v243, v243, v241
    v_mfma_f32_32x32x16_bf16 a[96:111], a[232:235], v[232:235], a[96:111]
    v_mov_b32 v247, v242
    v_mov_b32 v246, v244
    s_nop 0
    v_permlane32_swap_b32 v242, v247
    s_nop 0
    v_mfma_f32_32x32x16_bf16 a[112:127], a[236:239], v[232:235], a[112:127]
    s_nop 1
    v_add_f32 v247, v242, v247
    ds_write_b64 v10, v[246:247] offset:0
    v_accvgpr_read_b32 v16, a16
    v_mfma_f32_32x32x16_bf16 a[64:79], a[240:243], v[236:239], a[64:79]
    v_accvgpr_read_b32 v17, a17
    v_accvgpr_read_b32 v18, a18
    v_accvgpr_read_b32 v19, a19
    v_accvgpr_read_b32 v20, a20
    v_mfma_f32_32x32x16_bf16 a[80:95], a[244:247], v[236:239], a[80:95]
    v_accvgpr_read_b32 v21, a21
    v_accvgpr_read_b32 v22, a22
    v_accvgpr_read_b32 v23, a23
    v_accvgpr_read_b32 v24, a24
    v_mfma_f32_32x32x16_bf16 a[96:111], a[248:251], v[236:239], a[96:111]
    v_accvgpr_read_b32 v25, a25
    v_accvgpr_read_b32 v26, a26
    v_accvgpr_read_b32 v27, a27
    v_accvgpr_read_b32 v28, a28
    v_mfma_f32_32x32x16_bf16 a[112:127], a[252:255], v[236:239], a[112:127]
    v_accvgpr_read_b32 v29, a29
    v_accvgpr_read_b32 v30, a30
    v_accvgpr_read_b32 v31, a31
    s_waitcnt lgkmcnt(0)
    s_barrier
    ds_read_b128 v[48:51], v11 offset:0
    ds_read_b128 v[52:55], v11 offset:16
    ds_read_b128 v[64:67], v9 offset:0
    ds_read_b128 v[68:71], v9 offset:1024
    ds_read_b128 v[72:75], v9 offset:2048
    ds_read_b128 v[76:79], v9 offset:3072
    ds_read_b128 v[80:83], v9 offset:16384
    ds_read_b128 v[84:87], v9 offset:17408
    ds_read_b128 v[88:91], v9 offset:18432
    ds_read_b128 v[92:95], v9 offset:19456
    ds_read_b128 v[96:99], v4 offset:0
    ds_read_b128 v[100:103], v4 offset:1024
    ds_read_b128 v[104:107], v4 offset:2048
    ds_read_b128 v[108:111], v4 offset:3072
    ds_write_b128 v8, a[96:99] offset:4096
    ds_write_b128 v8, a[100:103] offset:5120
    ds_write_b128 v8, a[104:107] offset:6144
    ds_write_b128 v8, a[108:111] offset:7168
    ds_write_b128 v8, a[112:115] offset:12288
    ds_write_b128 v8, a[116:119] offset:13312
    ds_write_b128 v8, a[120:123] offset:14336
    ds_write_b128 v8, a[124:127] offset:15360
    ds_write_b128 v8, a[64:67] offset:20480
    ds_write_b128 v8, a[68:71] offset:21504
    ds_write_b128 v8, a[72:75] offset:22528
    ds_write_b128 v8, a[76:79] offset:23552
    v_mov_b32 v249, v243
    v_mov_b32 v248, v245
    s_nop 0
    v_permlane32_swap_b32 v243, v249
    s_nop 1
    v_add_f32 v249, v243, v249
    ds_write_b64 v10, v[248:249] offset:1024
    s_waitcnt lgkmcnt(15)
    v_max3_f32 v250, v48, v50, v52
    v_max_f32 v250, v250, v54
    v_sub_f32 v48, v48, v250
    v_sub_f32 v50, v50, v250
    v_sub_f32 v52, v52, v250
    v_sub_f32 v54, v54, v250
    v_exp_f32 v48, v48
    v_exp_f32 v50, v50
    v_exp_f32 v52, v52
    v_exp_f32 v54, v54
    s_nop 0
    v_mul_f32 v251, v48, v49
    v_fmac_f32 v251, v50, v51
    v_fmac_f32 v251, v52, v53
    v_fmac_f32 v251, v54, v55
    v_rcp_f32 v251, v251
    s_nop 0
    v_mul_f32 v48, v48, v251
    v_mul_f32 v50, v50, v251
    v_mul_f32 v52, v52, v251
    v_mul_f32 v54, v54, v251
    v_pk_mul_f32 v[16:17], v[16:17], v[50:51] op_sel_hi:[1,0]
    v_pk_mul_f32 v[18:19], v[18:19], v[50:51] op_sel_hi:[1,0]
    v_pk_mul_f32 v[20:21], v[20:21], v[50:51] op_sel_hi:[1,0]
    v_pk_mul_f32 v[22:23], v[22:23], v[50:51] op_sel_hi:[1,0]
    v_pk_mul_f32 v[24:25], v[24:25], v[50:51] op_sel_hi:[1,0]
    v_pk_mul_f32 v[26:27], v[26:27], v[50:51] op_sel_hi:[1,0]
    v_pk_mul_f32 v[28:29], v[28:29], v[50:51] op_sel_hi:[1,0]
    v_pk_mul_f32 v[30:31], v[30:31], v[50:51] op_sel_hi:[1,0]
    s_waitcnt lgkmcnt(15)
    v_pk_fma_f32 v[16:17], v[64:65], v[52:53], v[16:17] op_sel_hi:[1,0,1]
    v_pk_fma_f32 v[18:19], v[66:67], v[52:53], v[18:19] op_sel_hi:[1,0,1]
    v_pk_fma_f32 v[20:21], v[68:69], v[52:53], v[20:21] op_sel_hi:[1,0,1]
    v_pk_fma_f32 v[22:23], v[70:71], v[52:53], v[22:23] op_sel_hi:[1,0,1]
    v_pk_fma_f32 v[24:25], v[72:73], v[52:53], v[24:25] op_sel_hi:[1,0,1]
    v_pk_fma_f32 v[26:27], v[74:75], v[52:53], v[26:27] op_sel_hi:[1,0,1]
    v_pk_fma_f32 v[28:29], v[76:77], v[52:53], v[28:29] op_sel_hi:[1,0,1]
    v_pk_fma_f32 v[30:31], v[78:79], v[52:53], v[30:31] op_sel_hi:[1,0,1]
    s_waitcnt lgkmcnt(15)
    v_pk_fma_f32 v[16:17], v[80:81], v[54:55], v[16:17] op_sel_hi:[1,0,1]
    v_pk_fma_f32 v[18:19], v[82:83], v[54:55], v[18:19] op_sel_hi:[1,0,1]
    v_pk_fma_f32 v[20:21], v[84:85], v[54:55], v[20:21] op_sel_hi:[1,0,1]
    v_pk_fma_f32 v[22:23], v[86:87], v[54:55], v[22:23] op_sel_hi:[1,0,1]
    v_pk_fma_f32 v[24:25], v[88:89], v[54:55], v[24:25] op_sel_hi:[1,0,1]
    v_pk_fma_f32 v[26:27], v[90:91], v[54:55], v[26:27] op_sel_hi:[1,0,1]
    v_pk_fma_f32 v[28:29], v[92:93], v[54:55], v[28:29] op_sel_hi:[1,0,1]
    v_pk_fma_f32 v[30:31], v[94:95], v[54:55], v[30:31] op_sel_hi:[1,0,1]
    s_waitcnt lgkmcnt(13)
    v_pk_fma_f32 v[16:17], v[96:97], v[48:49], v[16:17] op_sel_hi:[1,0,1]
    v_pk_fma_f32 v[18:19], v[98:99], v[48:49], v[18:19] op_sel_hi:[1,0,1]
    v_pk_fma_f32 v[20:21], v[100:101], v[48:49], v[20:21] op_sel_hi:[1,0,1]
    v_pk_fma_f32 v[22:23], v[102:103], v[48:49], v[22:23] op_sel_hi:[1,0,1]
    v_pk_fma_f32 v[24:25], v[104:105], v[48:49], v[24:25] op_sel_hi:[1,0,1]
    v_pk_fma_f32 v[26:27], v[106:107], v[48:49], v[26:27] op_sel_hi:[1,0,1]
    v_pk_fma_f32 v[28:29], v[108:109], v[48:49], v[28:29] op_sel_hi:[1,0,1]
    v_pk_fma_f32 v[30:31], v[110:111], v[48:49], v[30:31] op_sel_hi:[1,0,1]
    v_cvt_pk_bf16_f32 v224, v16, v17
    v_cvt_pk_bf16_f32 v225, v18, v19
    v_cvt_pk_bf16_f32 v226, v20, v21
    v_cvt_pk_bf16_f32 v227, v22, v23
    v_cvt_pk_bf16_f32 v228, v24, v25
    v_cvt_pk_bf16_f32 v229, v26, v27
    v_cvt_pk_bf16_f32 v230, v28, v29
    v_cvt_pk_bf16_f32 v231, v30, v31
    s_nop 1
    v_permlane32_swap_b32 v224, v226
    v_permlane32_swap_b32 v225, v227
    v_permlane32_swap_b32 v228, v230
    v_permlane32_swap_b32 v229, v231
    buffer_store_dwordx4 v[224:227], v12, s[88:91], 0 offen
    buffer_store_dwordx4 v[228:231], v12, s[88:91], 0 offen offset:32
    v_accvgpr_read_b32 v32, a80
    v_accvgpr_read_b32 v33, a81
    v_accvgpr_read_b32 v34, a82
    v_accvgpr_read_b32 v35, a83
    v_accvgpr_read_b32 v36, a84
    v_accvgpr_read_b32 v37, a85
    v_accvgpr_read_b32 v38, a86
    v_accvgpr_read_b32 v39, a87
    v_accvgpr_read_b32 v40, a88
    v_accvgpr_read_b32 v41, a89
    v_accvgpr_read_b32 v42, a90
    v_accvgpr_read_b32 v43, a91
    v_accvgpr_read_b32 v44, a92
    v_accvgpr_read_b32 v45, a93
    v_accvgpr_read_b32 v46, a94
    v_accvgpr_read_b32 v47, a95
    s_waitcnt lgkmcnt(0)
    s_barrier
    ds_read_b128 v[56:59], v11 offset:1024
    ds_read_b128 v[60:63], v11 offset:1040
    ds_read_b128 v[112:115], v9 offset:4096
    ds_read_b128 v[116:119], v9 offset:5120
    ds_read_b128 v[120:123], v9 offset:6144
    ds_read_b128 v[124:127], v9 offset:7168
    ds_read_b128 v[128:131], v9 offset:20480
    ds_read_b128 v[132:135], v9 offset:21504
    ds_read_b128 v[136:139], v9 offset:22528
    ds_read_b128 v[140:143], v9 offset:23552
    ds_read_b128 v[144:147], v4 offset:4096
    ds_read_b128 v[148:151], v4 offset:5120
    ds_read_b128 v[152:155], v4 offset:6144
    ds_read_b128 v[156:159], v4 offset:7168
    s_waitcnt lgkmcnt(12)
    v_max3_f32 v250, v56, v58, v60
    v_max_f32 v250, v250, v62
    v_sub_f32 v56, v56, v250
    v_sub_f32 v58, v58, v250
    v_sub_f32 v60, v60, v250
    v_sub_f32 v62, v62, v250
    v_exp_f32 v56, v56
    v_exp_f32 v58, v58
    v_exp_f32 v60, v60
    v_exp_f32 v62, v62
    s_nop 0
    v_mul_f32 v251, v56, v57
    v_fmac_f32 v251, v58, v59
    v_fmac_f32 v251, v60, v61
    v_fmac_f32 v251, v62, v63
    v_rcp_f32 v251, v251
    s_nop 0
    v_mul_f32 v56, v56, v251
    v_mul_f32 v58, v58, v251
    v_mul_f32 v60, v60, v251
    v_mul_f32 v62, v62, v251
    v_pk_mul_f32 v[32:33], v[32:33], v[58:59] op_sel_hi:[1,0]
    v_pk_mul_f32 v[34:35], v[34:35], v[58:59] op_sel_hi:[1,0]
    v_pk_mul_f32 v[36:37], v[36:37], v[58:59] op_sel_hi:[1,0]
    v_pk_mul_f32 v[38:39], v[38:39], v[58:59] op_sel_hi:[1,0]
    v_pk_mul_f32 v[40:41], v[40:41], v[58:59] op_sel_hi:[1,0]
    v_pk_mul_f32 v[42:43], v[42:43], v[58:59] op_sel_hi:[1,0]
    v_pk_mul_f32 v[44:45], v[44:45], v[58:59] op_sel_hi:[1,0]
    v_pk_mul_f32 v[46:47], v[46:47], v[58:59] op_sel_hi:[1,0]
    s_waitcnt lgkmcnt(8)
    v_pk_fma_f32 v[32:33], v[112:113], v[60:61], v[32:33] op_sel_hi:[1,0,1]
    v_pk_fma_f32 v[34:35], v[114:115], v[60:61], v[34:35] op_sel_hi:[1,0,1]
    v_pk_fma_f32 v[36:37], v[116:117], v[60:61], v[36:37] op_sel_hi:[1,0,1]
    v_pk_fma_f32 v[38:39], v[118:119], v[60:61], v[38:39] op_sel_hi:[1,0,1]
    v_pk_fma_f32 v[40:41], v[120:121], v[60:61], v[40:41] op_sel_hi:[1,0,1]
    v_pk_fma_f32 v[42:43], v[122:123], v[60:61], v[42:43] op_sel_hi:[1,0,1]
    v_pk_fma_f32 v[44:45], v[124:125], v[60:61], v[44:45] op_sel_hi:[1,0,1]
    v_pk_fma_f32 v[46:47], v[126:127], v[60:61], v[46:47] op_sel_hi:[1,0,1]
    s_waitcnt lgkmcnt(4)
    v_pk_fma_f32 v[32:33], v[128:129], v[62:63], v[32:33] op_sel_hi:[1,0,1]
    v_pk_fma_f32 v[34:35], v[130:131], v[62:63], v[34:35] op_sel_hi:[1,0,1]
    v_pk_fma_f32 v[36:37], v[132:133], v[62:63], v[36:37] op_sel_hi:[1,0,1]
    v_pk_fma_f32 v[38:39], v[134:135], v[62:63], v[38:39] op_sel_hi:[1,0,1]
    v_pk_fma_f32 v[40:41], v[136:137], v[62:63], v[40:41] op_sel_hi:[1,0,1]
    v_pk_fma_f32 v[42:43], v[138:139], v[62:63], v[42:43] op_sel_hi:[1,0,1]
    v_pk_fma_f32 v[44:45], v[140:141], v[62:63], v[44:45] op_sel_hi:[1,0,1]
    v_pk_fma_f32 v[46:47], v[142:143], v[62:63], v[46:47] op_sel_hi:[1,0,1]
    s_waitcnt lgkmcnt(0)
    v_pk_fma_f32 v[32:33], v[144:145], v[56:57], v[32:33] op_sel_hi:[1,0,1]
    v_pk_fma_f32 v[34:35], v[146:147], v[56:57], v[34:35] op_sel_hi:[1,0,1]
    v_pk_fma_f32 v[36:37], v[148:149], v[56:57], v[36:37] op_sel_hi:[1,0,1]
    v_pk_fma_f32 v[38:39], v[150:151], v[56:57], v[38:39] op_sel_hi:[1,0,1]
    v_pk_fma_f32 v[40:41], v[152:153], v[56:57], v[40:41] op_sel_hi:[1,0,1]
    v_pk_fma_f32 v[42:43], v[154:155], v[56:57], v[42:43] op_sel_hi:[1,0,1]
    v_pk_fma_f32 v[44:45], v[156:157], v[56:57], v[44:45] op_sel_hi:[1,0,1]
    v_pk_fma_f32 v[46:47], v[158:159], v[56:57], v[46:47] op_sel_hi:[1,0,1]
    v_cvt_pk_bf16_f32 v232, v32, v33
    v_cvt_pk_bf16_f32 v233, v34, v35
    v_cvt_pk_bf16_f32 v234, v36, v37
    v_cvt_pk_bf16_f32 v235, v38, v39
    v_cvt_pk_bf16_f32 v236, v40, v41
    v_cvt_pk_bf16_f32 v237, v42, v43
    v_cvt_pk_bf16_f32 v238, v44, v45
    v_cvt_pk_bf16_f32 v239, v46, v47
    s_nop 1
    v_permlane32_swap_b32 v232, v234
    v_permlane32_swap_b32 v233, v235
    v_permlane32_swap_b32 v236, v238
    v_permlane32_swap_b32 v237, v239
    buffer_store_dwordx4 v[232:235], v12, s[88:91], s97 offen
    buffer_store_dwordx4 v[236:239], v12, s[88:91], s97 offen offset:32
    s_endpgm
L_tail_2:
    v_add_u32 v8, 0xc000, v4
    v_add_u32 v9, 0x10000, v4
    v_and_b32 v11, 31, v2
    v_lshlrev_b32 v12, 8, v11
    v_lshlrev_b32 v11, 5, v11
    v_add_u32 v11, 0x18000, v11
    v_add_u32 v10, 16, v11
    v_lshrrev_b32 v13, 5, v2
    v_lshl_add_u32 v12, v13, 4, v12
    s_lshl_b32 s101, s4, 19
    s_lshl_b32 s97, s5, 14
    s_add_u32 s101, s101, s97
    s_add_u32 s101, s101, 128
    v_add_u32 v12, s101, v12
    s_mov_b32 s97, 0x2000
    v_exp_f32 v199, v151
    ds_write_b128 v8, a[48:51] offset:0
    v_exp_f32 v200, v152
    ds_write_b128 v8, a[52:55] offset:1024
    v_add_f32 v241, v241, v198
    ds_write_b128 v8, a[56:59] offset:2048
    v_exp_f32 v201, v153
    ds_write_b128 v8, a[60:63] offset:3072
    v_add_f32 v241, v241, v199
    ds_write_b128 v8, a[0:3] offset:8192
    v_cvt_pk_bf16_f32 v232, v192, v193
    ds_write_b128 v8, a[4:7] offset:9216
    v_exp_f32 v202, v154
    ds_write_b128 v8, a[8:11] offset:10240
    v_exp_f32 v203, v155
    ds_write_b128 v8, a[12:15] offset:11264
    v_add_f32 v241, v241, v200
    ds_write_b128 v8, a[16:19] offset:16384
    v_exp_f32 v204, v156
    ds_write_b128 v8, a[20:23] offset:17408
    v_add_f32 v241, v241, v201
    ds_write_b128 v8, a[24:27] offset:18432
    v_cvt_pk_bf16_f32 v233, v194, v195
    ds_write_b128 v8, a[28:31] offset:19456
    v_add_f32 v241, v241, v202
    v_exp_f32 v205, v157
    v_add_f32 v241, v241, v203
    v_cvt_pk_bf16_f32 v234, v196, v197
    v_exp_f32 v206, v158
    v_add_f32 v241, v241, v204
    v_cvt_pk_bf16_f32 v235, v198, v199
    v_add_f32 v241, v241, v205
    v_exp_f32 v207, v159
    v_add_f32 v241, v241, v206
    v_add_f32 v241, v241, v207
    v_cmp_lt_f32 vcc, s6, v241
    s_nop 0
    s_cbranch_vccnz L_stub_32
L_ret_32:
    v_mfma_f32_32x32x16_bf16 a[64:79], a[224:227], v[232:235], a[64:79]
    s_nop 0
    v_cvt_pk_bf16_f32 v236, v200, v201
    v_cvt_pk_bf16_f32 v237, v202, v203
    v_mfma_f32_32x32x16_bf16 a[80:95], a[228:231], v[232:235], a[80:95]
    s_nop 0
    v_cvt_pk_bf16_f32 v238, v204, v205
    v_cvt_pk_bf16_f32 v239, v206, v207
    v_add_f32 v243, v243, v241
    v_mfma_f32_32x32x16_bf16 a[96:111], a[232:235], v[232:235], a[96:111]
    v_mov_b32 v247, v242
    v_mov_b32 v246, v244
    s_nop 0
    v_permlane32_swap_b32 v242, v247
    s_nop 0
    v_mfma_f32_32x32x16_bf16 a[112:127], a[236:239], v[232:235], a[112:127]
    s_nop 1
    v_add_f32 v247, v242, v247
    ds_write_b64 v10, v[246:247] offset:0
    v_accvgpr_read_b32 v16, a32
    v_mfma_f32_32x32x16_bf16 a[64:79], a[240:243], v[236:239], a[64:79]
    v_accvgpr_read_b32 v17, a33
    v_accvgpr_read_b32 v18, a34
    v_accvgpr_read_b32 v19, a35
    v_accvgpr_read_b32 v20, a36
    v_mfma_f32_32x32x16_bf16 a[80:95], a[244:247], v[236:239], a[80:95]
    v_accvgpr_read_b32 v21, a37
    v_accvgpr_read_b32 v22, a38
    v_accvgpr_read_b32 v23, a39
    v_accvgpr_read_b32 v24, a40
    v_mfma_f32_32x32x16_bf16 a[96:111], a[248:251], v[236:239], a[96:111]
    v_accvgpr_read_b32 v25, a41
    v_accvgpr_read_b32 v26, a42
    v_accvgpr_read_b32 v27, a43
    v_accvgpr_read_b32 v28, a44
    v_mfma_f32_32x32x16_bf16 a[112:127], a[252:255], v[236:239], a[112:127]
    v_accvgpr_read_b32 v29, a45
    v_accvgpr_read_b32 v30, a46
    v_accvgpr_read_b32 v31, a47
    s_waitcnt lgkmcnt(0)
    s_barrier
    ds_read_b128 v[48:51], v11 offset:0
    ds_read_b128 v[52:55], v11 offset:16
    ds_read_b128 v[64:67], v9 offset:24576
    ds_read_b128 v[68:71], v9 offset:25600
    ds_read_b128 v[72:75], v9 offset:26624
    ds_read_b128 v[76:79], v9 offset:27648
    ds_read_b128 v[80:83], v4 offset:8192
    ds_read_b128 v[84:87], v4 offset:9216
    ds_read_b128 v[88:91], v4 offset:10240
    ds_read_b128 v[92:95], v4 offset:11264
    ds_read_b128 v[96:99], v4 offset:24576
    ds_read_b128 v[100:103], v4 offset:25600
    ds_read_b128 v[104:107], v4 offset:26624
    ds_read_b128 v[108:111], v4 offset:27648
    ds_write_b128 v8, a[112:115] offset:4096
    ds_write_b128 v8, a[116:119] offset:5120
    ds_write_b128 v8, a[120:123] offset:6144
    ds_write_b128 v8, a[124:127] offset:7168
    ds_write_b128 v8, a[64:67] offset:12288
    ds_write_b128 v8, a[68:71] offset:13312
    ds_write_b128 v8, a[72:75] offset:14336
    ds_write_b128 v8, a[76:79] offset:15360
    ds_write_b128 v8, a[80:83] offset:20480
    ds_write_b128 v8, a[84:87] offset:21504
    ds_write_b128 v8, a[88:91] offset:22528
    ds_write_b128 v8, a[92:95] offset:23552
    v_mov_b32 v249, v243
    v_mov_b32 v248, v245
    s_nop 0
    v_permlane32_swap_b32 v243, v249
    s_nop 1
    v_add_f32 v249, v243, v249
    ds_write_b64 v10, v[248:249] offset:1024
    s_waitcnt lgkmcnt(15)
    v_max3_f32 v250, v48, v50, v52
    v_max_f32 v250, v250, v54
    v_sub_f32 v48, v48, v250
    v_sub_f32 v50, v50, v250
    v_sub_f32 v52, v52, v250
    v_sub_f32 v54, v54, v250
    v_exp_f32 v48, v48
    v_exp_f32 v50, v50
    v_exp_f32 v52, v52
    v_exp_f32 v54, v54
    s_nop 0
    v_mul_f32 v251, v48, v49
    v_fmac_f32 v251, v50, v51
    v_fmac_f32 v251, v52, v53
    v_fmac_f32 v251, v54, v55
    v_rcp_f32 v251, v251
    s_nop 0
    v_mul_f32 v48, v48, v251
    v_mul_f32 v50, v50, v251
    v_mul_f32 v52, v52, v251
    v_mul_f32 v54, v54, v251
    v_pk_mul_f32 v[16:17], v[16:17], v[52:53] op_sel_hi:[1,0]
    v_pk_mul_f32 v[18:19], v[18:19], v[52:53] op_sel_hi:[1,0]
    v_pk_mul_f32 v[20:21], v[20:21], v[52:53] op_sel_hi:[1,0]
    v_pk_mul_f32 v[22:23], v[22:23], v[52:53] op_sel_hi:[1,0]
    v_pk_mul_f32 v[24:25], v[24:25], v[52:53] op_sel_hi:[1,0]
    v_pk_mul_f32 v[26:27], v[26:27], v[52:53] op_sel_hi:[1,0]
    v_pk_mul_f32 v[28:29], v[28:29], v[52:53] op_sel_hi:[1,0]
    v_pk_mul_f32 v[30:31], v[30:31], v[52:53] op_sel_hi:[1,0]
    s_waitcnt lgkmcnt(15)
    v_pk_fma_f32 v[16:17], v[64:65], v[54:55], v[16:17] op_sel_hi:[1,0,1]
    v_pk_fma_f32 v[18:19], v[66:67], v[54:55], v[18:19] op_sel_hi:[1,0,1]
    v_pk_fma_f32 v[20:21], v[68:69], v[54:55], v[20:21] op_sel_hi:[1,0,1]
    v_pk_fma_f32 v[22:23], v[70:71], v[54:55], v[22:23] op_sel_hi:[1,0,1]
    v_pk_fma_f32 v[24:25], v[72:73], v[54:55], v[24:25] op_sel_hi:[1,0,1]
    v_pk_fma_f32 v[26:27], v[74:75], v[54:55], v[26:27] op_sel_hi:[1,0,1]
    v_pk_fma_f32 v[28:29], v[76:77], v[54:55], v[28:29] op_sel_hi:[1,0,1]
    v_pk_fma_f32 v[30:31], v[78:79], v[54:55], v[30:31] op_sel_hi:[1,0,1]
    s_waitcnt lgkmcnt(15)
    v_pk_fma_f32 v[16:17], v[80:81], v[48:49], v[16:17] op_sel_hi:[1,0,1]
    v_pk_fma_f32 v[18:19], v[82:83], v[48:49], v[18:19] op_sel_hi:[1,0,1]
    v_pk_fma_f32 v[20:21], v[84:85], v[48:49], v[20:21] op_sel_hi:[1,0,1]
    v_pk_fma_f32 v[22:23], v[86:87], v[48:49], v[22:23] op_sel_hi:[1,0,1]
    v_pk_fma_f32 v[24:25], v[88:89], v[48:49], v[24:25] op_sel_hi:[1,0,1]
    v_pk_fma_f32 v[26:27], v[90:91], v[48:49], v[26:27] op_sel_hi:[1,0,1]
    v_pk_fma_f32 v[28:29], v[92:93], v[48:49], v[28:29] op_sel_hi:[1,0,1]
    v_pk_fma_f32 v[30:31], v[94:95], v[48:49], v[30:31] op_sel_hi:[1,0,1]
    s_waitcnt lgkmcnt(13)
    v_pk_fma_f32 v[16:17], v[96:97], v[50:51], v[16:17] op_sel_hi:[1,0,1]
    v_pk_fma_f32 v[18:19], v[98:99], v[50:51], v[18:19] op_sel_hi:[1,0,1]
    v_pk_fma_f32 v[20:21], v[100:101], v[50:51], v[20:21] op_sel_hi:[1,0,1]
    v_pk_fma_f32 v[22:23], v[102:103], v[50:51], v[22:23] op_sel_hi:[1,0,1]
    v_pk_fma_f32 v[24:25], v[104:105], v[50:51], v[24:25] op_sel_hi:[1,0,1]
    v_pk_fma_f32 v[26:27], v[106:107], v[50:51], v[26:27] op_sel_hi:[1,0,1]
    v_pk_fma_f32 v[28:29], v[108:109], v[50:51], v[28:29] op_sel_hi:[1,0,1]
    v_pk_fma_f32 v[30:31], v[110:111], v[50:51], v[30:31] op_sel_hi:[1,0,1]
    v_cvt_pk_bf16_f32 v224, v16, v17
    v_cvt_pk_bf16_f32 v225, v18, v19
    v_cvt_pk_bf16_f32 v226, v20, v21
    v_cvt_pk_bf16_f32 v227, v22, v23
    v_cvt_pk_bf16_f32 v228, v24, v25
    v_cvt_pk_bf16_f32 v229, v26, v27
    v_cvt_pk_bf16_f32 v230, v28, v29
    v_cvt_pk_bf16_f32 v231, v30, v31
    s_nop 1
    v_permlane32_swap_b32 v224, v226
    v_permlane32_swap_b32 v225, v227
    v_permlane32_swap_b32 v228, v230
    v_permlane32_swap_b32 v229, v231
    buffer_store_dwordx4 v[224:227], v12, s[88:91], 0 offen
    buffer_store_dwordx4 v[228:231], v12, s[88:91], 0 offen offset:32
    v_accvgpr_read_b32 v32, a96
    v_accvgpr_read_b32 v33, a97
    v_accvgpr_read_b32 v34, a98
    v_accvgpr_read_b32 v35, a99
    v_accvgpr_read_b32 v36, a100
    v_accvgpr_read_b32 v37, a101
    v_accvgpr_read_b32 v38, a102
    v_accvgpr_read_b32 v39, a103
    v_accvgpr_read_b32 v40, a104
    v_accvgpr_read_b32 v41, a105
    v_accvgpr_read_b32 v42, a106
    v_accvgpr_read_b32 v43, a107
    v_accvgpr_read_b32 v44, a108
    v_accvgpr_read_b32 v45, a109
    v_accvgpr_read_b32 v46, a110
    v_accvgpr_read_b32 v47, a111
    s_waitcnt lgkmcnt(0)
    s_barrier
    ds_read_b128 v[56:59], v11 offset:1024
    ds_read_b128 v[60:63], v11 offset:1040
    ds_read_b128 v[112:115], v9 offset:28672
    ds_read_b128 v[116:119], v9 offset:29696
    ds_read_b128 v[120:123], v9 offset:30720
    ds_read_b128 v[124:127], v9 offset:31744
    ds_read_b128 v[128:131], v4 offset:12288
    ds_read_b128 v[132:135], v4 offset:13312
    ds_read_b128 v[136:139], v4 offset:14336
    ds_read_b128 v[140:143], v4 offset:15360
    ds_read_b128 v[144:147], v4 offset:28672
    ds_read_b128 v[148:151], v4 offset:29696
    ds_read_b128 v[152:155], v4 offset:30720
    ds_read_b128 v[156:159], v4 offset:31744
    s_waitcnt lgkmcnt(12)
    v_max3_f32 v250, v56, v58, v60
    v_max_f32 v250, v250, v62
    v_sub_f32 v56, v56, v250
    v_sub_f32 v58, v58, v250
    v_sub_f32 v60, v60, v250
    v_sub_f32 v62, v62, v250
    v_exp_f32 v56, v56
    v_exp_f32 v58, v58
    v_exp_f32 v60, v60
    v_exp_f32 v62, v62
    s_nop 0
    v_mul_f32 v251, v56, v57
    v_fmac_f32 v251, v58, v59
    v_fmac_f32 v251, v60, v61
    v_fmac_f32 v251, v62, v63
    v_rcp_f32 v251, v251
    s_nop 0
    v_mul_f32 v56, v56, v251
    v_mul_f32 v58, v58, v251
    v_mul_f32 v60, v60, v251
    v_mul_f32 v62, v62, v251
    v_pk_mul_f32 v[32:33], v[32:33], v[60:61] op_sel_hi:[1,0]
    v_pk_mul_f32 v[34:35], v[34:35], v[60:61] op_sel_hi:[1,0]
    v_pk_mul_f32 v[36:37], v[36:37], v[60:61] op_sel_hi:[1,0]
    v_pk_mul_f32 v[38:39], v[38:39], v[60:61] op_sel_hi:[1,0]
    v_pk_mul_f32 v[40:41], v[40:41], v[60:61] op_sel_hi:[1,0]
    v_pk_mul_f32 v[42:43], v[42:43], v[60:61] op_sel_hi:[1,0]
    v_pk_mul_f32 v[44:45], v[44:45], v[60:61] op_sel_hi:[1,0]
    v_pk_mul_f32 v[46:47], v[46:47], v[60:61] op_sel_hi:[1,0]
    s_waitcnt lgkmcnt(8)
    v_pk_fma_f32 v[32:33], v[112:113], v[62:63], v[32:33] op_sel_hi:[1,0,1]
    v_pk_fma_f32 v[34:35], v[114:115], v[62:63], v[34:35] op_sel_hi:[1,0,1]
    v_pk_fma_f32 v[36:37], v[116:117], v[62:63], v[36:37] op_sel_hi:[1,0,1]
    v_pk_fma_f32 v[38:39], v[118:119], v[62:63], v[38:39] op_sel_hi:[1,0,1]
    v_pk_fma_f32 v[40:41], v[120:121], v[62:63], v[40:41] op_sel_hi:[1,0,1]
    v_pk_fma_f32 v[42:43], v[122:123], v[62:63], v[42:43] op_sel_hi:[1,0,1]
    v_pk_fma_f32 v[44:45], v[124:125], v[62:63], v[44:45] op_sel_hi:[1,0,1]
    v_pk_fma_f32 v[46:47], v[126:127], v[62:63], v[46:47] op_sel_hi:[1,0,1]
    s_waitcnt lgkmcnt(4)
    v_pk_fma_f32 v[32:33], v[128:129], v[56:57], v[32:33] op_sel_hi:[1,0,1]
    v_pk_fma_f32 v[34:35], v[130:131], v[56:57], v[34:35] op_sel_hi:[1,0,1]
    v_pk_fma_f32 v[36:37], v[132:133], v[56:57], v[36:37] op_sel_hi:[1,0,1]
    v_pk_fma_f32 v[38:39], v[134:135], v[56:57], v[38:39] op_sel_hi:[1,0,1]
    v_pk_fma_f32 v[40:41], v[136:137], v[56:57], v[40:41] op_sel_hi:[1,0,1]
    v_pk_fma_f32 v[42:43], v[138:139], v[56:57], v[42:43] op_sel_hi:[1,0,1]
    v_pk_fma_f32 v[44:45], v[140:141], v[56:57], v[44:45] op_sel_hi:[1,0,1]
    v_pk_fma_f32 v[46:47], v[142:143], v[56:57], v[46:47] op_sel_hi:[1,0,1]
    s_waitcnt lgkmcnt(0)
    v_pk_fma_f32 v[32:33], v[144:145], v[58:59], v[32:33] op_sel_hi:[1,0,1]
    v_pk_fma_f32 v[34:35], v[146:147], v[58:59], v[34:35] op_sel_hi:[1,0,1]
    v_pk_fma_f32 v[36:37], v[148:149], v[58:59], v[36:37] op_sel_hi:[1,0,1]
    v_pk_fma_f32 v[38:39], v[150:151], v[58:59], v[38:39] op_sel_hi:[1,0,1]
    v_pk_fma_f32 v[40:41], v[152:153], v[58:59], v[40:41] op_sel_hi:[1,0,1]
    v_pk_fma_f32 v[42:43], v[154:155], v[58:59], v[42:43] op_sel_hi:[1,0,1]
    v_pk_fma_f32 v[44:45], v[156:157], v[58:59], v[44:45] op_sel_hi:[1,0,1]
    v_pk_fma_f32 v[46:47], v[158:159], v[58:59], v[46:47] op_sel_hi:[1,0,1]
    v_cvt_pk_bf16_f32 v232, v32, v33
    v_cvt_pk_bf16_f32 v233, v34, v35
    v_cvt_pk_bf16_f32 v234, v36, v37
    v_cvt_pk_bf16_f32 v235, v38, v39
    v_cvt_pk_bf16_f32 v236, v40, v41
    v_cvt_pk_bf16_f32 v237, v42, v43
    v_cvt_pk_bf16_f32 v238, v44, v45
    v_cvt_pk_bf16_f32 v239, v46, v47
    s_nop 1
    v_permlane32_swap_b32 v232, v234
    v_permlane32_swap_b32 v233, v235
    v_permlane32_swap_b32 v236, v238
    v_permlane32_swap_b32 v237, v239
    buffer_store_dwordx4 v[232:235], v12, s[88:91], s97 offen
    buffer_store_dwordx4 v[236:239], v12, s[88:91], s97 offen offset:32
    s_endpgm
L_tail_3:
    v_add_u32 v8, 0x12000, v4
    v_add_u32 v9, 0x10000, v4
    v_and_b32 v11, 31, v2
    v_lshlrev_b32 v12, 8, v11
    v_lshlrev_b32 v11, 5, v11
    v_add_u32 v11, 0x18000, v11
    v_add_u32 v10, 24, v11
    v_lshrrev_b32 v13, 5, v2
    v_lshl_add_u32 v12, v13, 4, v12
    s_lshl_b32 s101, s4, 19
    s_lshl_b32 s97, s5, 14
    s_add_u32 s101, s101, s97
    s_add_u32 s101, s101, 192
    v_add_u32 v12, s101, v12
    s_mov_b32 s97, 0x2000
    v_exp_f32 v199, v151
    ds_write_b128 v8, a[0:3] offset:0
    v_exp_f32 v200, v152
    ds_write_b128 v8, a[4:7] offset:1024
    v_add_f32 v241, v241, v198
    ds_write_b128 v8, a[8:11] offset:2048
    v_exp_f32 v201, v153
    ds_write_b128 v8, a[12:15] offset:3072
    v_add_f32 v241, v241, v199
    ds_write_b128 v8, a[16:19] offset:8192
    v_cvt_pk_bf16_f32 v232, v192, v193
    ds_write_b128 v8, a[20:23] offset:9216
    v_exp_f32 v202, v154
    ds_write_b128 v8, a[24:27] offset:10240
    v_exp_f32 v203, v155
    ds_write_b128 v8, a[28:31] offset:11264
    v_add_f32 v241, v241, v200
    ds_write_b128 v8, a[32:35] offset:16384
    v_exp_f32 v204, v156
    ds_write_b128 v8, a[36:39] offset:17408
    v_add_f32 v241, v241, v201
    ds_write_b128 v8, a[40:43] offset:18432
    v_cvt_pk_bf16_f32 v233, v194, v195
    ds_write_b128 v8, a[44:47] offset:19456
    v_add_f32 v241, v241, v202
    v_exp_f32 v205, v157
    v_add_f32 v241, v241, v203
    v_cvt_pk_bf16_f32 v234, v196, v197
    v_exp_f32 v206, v158
    v_add_f32 v241, v241, v204
    v_cvt_pk_bf16_f32 v235, v198, v199
    v_add_f32 v241, v241, v205
    v_exp_f32 v207, v159
    v_add_f32 v241, v241, v206
    v_add_f32 v241, v241, v207
    v_cmp_lt_f32 vcc, s6, v241
    s_nop 0
    s_cbranch_vccnz L_stub_33
L_ret_33:
    v_mfma_f32_32x32x16_bf16 a[64:79], a[224:227], v[232:235], a[64:79]
    s_nop 0
    v_cvt_pk_bf16_f32 v236, v200, v201
    v_cvt_pk_bf16_f32 v237, v202, v203
    v_mfma_f32_32x32x16_bf16 a[80:95], a[228:231], v[232:235], a[80:95]
    s_nop 0
    v_cvt_pk_bf16_f32 v238, v204, v205
    v_cvt_pk_bf16_f32 v239, v206, v207
    v_add_f32 v243, v243, v241
    v_mfma_f32_32x32x16_bf16 a[96:111], a[232:235], v[232:235], a[96:111]
    v_mov_b32 v247, v242
    v_mov_b32 v246, v244
    s_nop 0
    v_permlane32_swap_b32 v242, v247
    s_nop 0
    v_mfma_f32_32x32x16_bf16 a[112:127], a[236:239], v[232:235], a[112:127]
    s_nop 1
    v_add_f32 v247, v242, v247
    ds_write_b64 v10, v[246:247] offset:0
    v_accvgpr_read_b32 v16, a48
    v_mfma_f32_32x32x16_bf16 a[64:79], a[240:243], v[236:239], a[64:79]
    v_accvgpr_read_b32 v17, a49
    v_accvgpr_read_b32 v18, a50
    v_accvgpr_read_b32 v19, a51
    v_accvgpr_read_b32 v20, a52
    v_mfma_f32_32x32x16_bf16 a[80:95], a[244:247], v[236:239], a[80:95]
    v_accvgpr_read_b32 v21, a53
    v_accvgpr_read_b32 v22, a54
    v_accvgpr_read_b32 v23, a55
    v_accvgpr_read_b32 v24, a56
    v_mfma_f32_32x32x16_bf16 a[96:111], a[248:251], v[236:239], a[96:111]
    v_accvgpr_read_b32 v25, a57
    v_accvgpr_read_b32 v26, a58
    v_accvgpr_read_b32 v27, a59
    v_accvgpr_read_b32 v28, a60
    v_mfma_f32_32x32x16_bf16 a[112:127], a[252:255], v[236:239], a[112:127]
    v_accvgpr_read_b32 v29, a61
    v_accvgpr_read_b32 v30, a62
    v_accvgpr_read_b32 v31, a63
    s_waitcnt lgkmcnt(0)
    s_barrier
    ds_read_b128 v[48:51], v11 offset:0
    ds_read_b128 v[52:55], v11 offset:16
    ds_read_b128 v[64:67], v4 offset:16384
    ds_read_b128 v[68:71], v4 offset:17408
    ds_read_b128 v[72:75], v4 offset:18432
    ds_read_b128 v[76:79], v4 offset:19456
    ds_read_b128 v[80:83], v4 offset:32768
    ds_read_b128 v[84:87], v4 offset:33792
    ds_read_b128 v[88:91], v4 offset:34816
    ds_read_b128 v[92:95], v4 offset:35840
    ds_read_b128 v[96:99], v4 offset:49152
    ds_read_b128 v[100:103], v4 offset:50176
    ds_read_b128 v[104:107], v4 offset:51200
    ds_read_b128 v[108:111], v4 offset:52224
    ds_write_b128 v8, a[64:67] offset:4096
    ds_write_b128 v8, a[68:71] offset:5120
    ds_write_b128 v8, a[72:75] offset:6144
    ds_write_b128 v8, a[76:79] offset:7168
    ds_write_b128 v8, a[80:83] offset:12288
    ds_write_b128 v8, a[84:87] offset:13312
    ds_write_b128 v8, a[88:91] offset:14336
    ds_write_b128 v8, a[92:95] offset:15360
    ds_write_b128 v8, a[96:99] offset:20480
    ds_write_b128 v8, a[100:103] offset:21504
    ds_write_b128 v8, a[104:107] offset:22528
    ds_write_b128 v8, a[108:111] offset:23552
    v_mov_b32 v249, v243
    v_mov_b32 v248, v245
    s_nop 0
    v_permlane32_swap_b32 v243, v249
    s_nop 1
    v_add_f32 v249, v243, v249
    ds_write_b64 v10, v[248:249] offset:1024
    s_waitcnt lgkmcnt(15)
    v_max3_f32 v250, v48, v50, v52
    v_max_f32 v250, v250, v54
    v_sub_f32 v48, v48, v250
    v_sub_f32 v50, v50, v250
    v_sub_f32 v52, v52, v250
    v_sub_f32 v54, v54, v250
    v_exp_f32 v48, v48
    v_exp_f32 v50, v50
    v_exp_f32 v52, v52
    v_exp_f32 v54, v54
    s_nop 0
    v_mul_f32 v251, v48, v49
    v_fmac_f32 v251, v50, v51
    v_fmac_f32 v251, v52, v53
    v_fmac_f32 v251, v54, v55
    v_rcp_f32 v251, v251
    s_nop 0
    v_mul_f32 v48, v48, v251
    v_mul_f32 v50, v50, v251
    v_mul_f32 v52, v52, v251
    v_mul_f32 v54, v54, v251
    v_pk_mul_f32 v[16:17], v[16:17], v[54:55] op_sel_hi:[1,0]
    v_pk_mul_f32 v[18:19], v[18:19], v[54:55] op_sel_hi:[1,0]
    v_pk_mul_f32 v[20:21], v[20:21], v[54:55] op_sel_hi:[1,0]
    v_pk_mul_f32 v[22:23], v[22:23], v[54:55] op_sel_hi:[1,0]
    v_pk_mul_f32 v[24:25], v[24:25], v[54:55] op_sel_hi:[1,0]
    v_pk_mul_f32 v[26:27], v[26:27], v[54:55] op_sel_hi:[1,0]
    v_pk_mul_f32 v[28:29], v[28:29], v[54:55] op_sel_hi:[1,0]
    v_pk_mul_f32 v[30:31], v[30:31], v[54:55] op_sel_hi:[1,0]
    s_waitcnt lgkmcnt(15)
    v_pk_fma_f32 v[16:17], v[64:65], v[48:49], v[16:17] op_sel_hi:[1,0,1]
    v_pk_fma_f32 v[18:19], v[66:67], v[48:49], v[18:19] op_sel_hi:[1,0,1]
    v_pk_fma_f32 v[20:21], v[68:69], v[48:49], v[20:21] op_sel_hi:[1,0,1]
    v_pk_fma_f32 v[22:23], v[70:71], v[48:49], v[22:23] op_sel_hi:[1,0,1]
    v_pk_fma_f32 v[24:25], v[72:73], v[48:49], v[24:25] op_sel_hi:[1,0,1]
    v_pk_fma_f32 v[26:27], v[74:75], v[48:49], v[26:27] op_sel_hi:[1,0,1]
    v_pk_fma_f32 v[28:29], v[76:77], v[48:49], v[28:29] op_sel_hi:[1,0,1]
    v_pk_fma_f32 v[30:31], v[78:79], v[48:49], v[30:31] op_sel_hi:[1,0,1]
    s_waitcnt lgkmcnt(15)
    v_pk_fma_f32 v[16:17], v[80:81], v[50:51], v[16:17] op_sel_hi:[1,0,1]
    v_pk_fma_f32 v[18:19], v[82:83], v[50:51], v[18:19] op_sel_hi:[1,0,1]
    v_pk_fma_f32 v[20:21], v[84:85], v[50:51], v[20:21] op_sel_hi:[1,0,1]
    v_pk_fma_f32 v[22:23], v[86:87], v[50:51], v[22:23] op_sel_hi:[1,0,1]
    v_pk_fma_f32 v[24:25], v[88:89], v[50:51], v[24:25] op_sel_hi:[1,0,1]
    v_pk_fma_f32 v[26:27], v[90:91], v[50:51], v[26:27] op_sel_hi:[1,0,1]
    v_pk_fma_f32 v[28:29], v[92:93], v[50:51], v[28:29] op_sel_hi:[1,0,1]
    v_pk_fma_f32 v[30:31], v[94:95], v[50:51], v[30:31] op_sel_hi:[1,0,1]
    s_waitcnt lgkmcnt(13)
    v_pk_fma_f32 v[16:17], v[96:97], v[52:53], v[16:17] op_sel_hi:[1,0,1]
    v_pk_fma_f32 v[18:19], v[98:99], v[52:53], v[18:19] op_sel_hi:[1,0,1]
    v_pk_fma_f32 v[20:21], v[100:101], v[52:53], v[20:21] op_sel_hi:[1,0,1]
    v_pk_fma_f32 v[22:23], v[102:103], v[52:53], v[22:23] op_sel_hi:[1,0,1]
    v_pk_fma_f32 v[24:25], v[104:105], v[52:53], v[24:25] op_sel_hi:[1,0,1]
    v_pk_fma_f32 v[26:27], v[106:107], v[52:53], v[26:27] op_sel_hi:[1,0,1]
    v_pk_fma_f32 v[28:29], v[108:109], v[52:53], v[28:29] op_sel_hi:[1,0,1]
    v_pk_fma_f32 v[30:31], v[110:111], v[52:53], v[30:31] op_sel_hi:[1,0,1]
    v_cvt_pk_bf16_f32 v224, v16, v17
    v_cvt_pk_bf16_f32 v225, v18, v19
    v_cvt_pk_bf16_f32 v226, v20, v21
    v_cvt_pk_bf16_f32 v227, v22, v23
    v_cvt_pk_bf16_f32 v228, v24, v25
    v_cvt_pk_bf16_f32 v229, v26, v27
    v_cvt_pk_bf16_f32 v230, v28, v29
    v_cvt_pk_bf16_f32 v231, v30, v31
    s_nop 1
    v_permlane32_swap_b32 v224, v226
    v_permlane32_swap_b32 v225, v227
    v_permlane32_swap_b32 v228, v230
    v_permlane32_swap_b32 v229, v231
    buffer_store_dwordx4 v[224:227], v12, s[88:91], 0 offen
    buffer_store_dwordx4 v[228:231], v12, s[88:91], 0 offen offset:32
    v_accvgpr_read_b32 v32, a112
    v_accvgpr_read_b32 v33, a113
    v_accvgpr_read_b32 v34, a114
    v_accvgpr_read_b32 v35, a115
    v_accvgpr_read_b32 v36, a116
    v_accvgpr_read_b32 v37, a117
    v_accvgpr_read_b32 v38, a118
    v_accvgpr_read_b32 v39, a119
    v_accvgpr_read_b32 v40, a120
    v_accvgpr_read_b32 v41, a121
    v_accvgpr_read_b32 v42, a122
    v_accvgpr_read_b32 v43, a123
    v_accvgpr_read_b32 v44, a124
    v_accvgpr_read_b32 v45, a125
    v_accvgpr_read_b32 v46, a126
    v_accvgpr_read_b32 v47, a127
    s_waitcnt lgkmcnt(0)
    s_barrier
    ds_read_b128 v[56:59], v11 offset:1024
    ds_read_b128 v[60:63], v11 offset:1040
    ds_read_b128 v[112:115], v4 offset:20480
    ds_read_b128 v[116:119], v4 offset:21504
    ds_read_b128 v[120:123], v4 offset:22528
    ds_read_b128 v[124:127], v4 offset:23552
    ds_read_b128 v[128:131], v4 offset:36864
    ds_read_b128 v[132:135], v4 offset:37888
    ds_read_b128 v[136:139], v4 offset:38912
    ds_read_b128 v[140:143], v4 offset:39936
    ds_read_b128 v[144:147], v4 offset:53248
    ds_read_b128 v[148:151], v4 offset:54272
    ds_read_b128 v[152:155], v4 offset:55296
    ds_read_b128 v[156:159], v4 offset:56320
    s_waitcnt lgkmcnt(12)
    v_max3_f32 v250, v56, v58, v60
    v_max_f32 v250, v250, v62
    v_sub_f32 v56, v56, v250
    v_sub_f32 v58, v58, v250
    v_sub_f32 v60, v60, v250
    v_sub_f32 v62, v62, v250
    v_exp_f32 v56, v56
    v_exp_f32 v58, v58
    v_exp_f32 v60, v60
    v_exp_f32 v62, v62
    s_nop 0
    v_mul_f32 v251, v56, v57
    v_fmac_f32 v251, v58, v59
    v_fmac_f32 v251, v60, v61
    v_fmac_f32 v251, v62, v63
    v_rcp_f32 v251, v251
    s_nop 0
    v_mul_f32 v56, v56, v251
    v_mul_f32 v58, v58, v251
    v_mul_f32 v60, v60, v251
    v_mul_f32 v62, v62, v251
    v_pk_mul_f32 v[32:33], v[32:33], v[62:63] op_sel_hi:[1,0]
    v_pk_mul_f32 v[34:35], v[34:35], v[62:63] op_sel_hi:[1,0]
    v_pk_mul_f32 v[36:37], v[36:37], v[62:63] op_sel_hi:[1,0]
    v_pk_mul_f32 v[38:39], v[38:39], v[62:63] op_sel_hi:[1,0]
    v_pk_mul_f32 v[40:41], v[40:41], v[62:63] op_sel_hi:[1,0]
    v_pk_mul_f32 v[42:43], v[42:43], v[62:63] op_sel_hi:[1,0]
    v_pk_mul_f32 v[44:45], v[44:45], v[62:63] op_sel_hi:[1,0]
    v_pk_mul_f32 v[46:47], v[46:47], v[62:63] op_sel_hi:[1,0]
    s_waitcnt lgkmcnt(8)
    v_pk_fma_f32 v[32:33], v[112:113], v[56:57], v[32:33] op_sel_hi:[1,0,1]
    v_pk_fma_f32 v[34:35], v[114:115], v[56:57], v[34:35] op_sel_hi:[1,0,1]
    v_pk_fma_f32 v[36:37], v[116:117], v[56:57], v[36:37] op_sel_hi:[1,0,1]
    v_pk_fma_f32 v[38:39], v[118:119], v[56:57], v[38:39] op_sel_hi:[1,0,1]
    v_pk_fma_f32 v[40:41], v[120:121], v[56:57], v[40:41] op_sel_hi:[1,0,1]
    v_pk_fma_f32 v[42:43], v[122:123], v[56:57], v[42:43] op_sel_hi:[1,0,1]
    v_pk_fma_f32 v[44:45], v[124:125], v[56:57], v[44:45] op_sel_hi:[1,0,1]
    v_pk_fma_f32 v[46:47], v[126:127], v[56:57], v[46:47] op_sel_hi:[1,0,1]
    s_waitcnt lgkmcnt(4)
    v_pk_fma_f32 v[32:33], v[128:129], v[58:59], v[32:33] op_sel_hi:[1,0,1]
    v_pk_fma_f32 v[34:35], v[130:131], v[58:59], v[34:35] op_sel_hi:[1,0,1]
    v_pk_fma_f32 v[36:37], v[132:133], v[58:59], v[36:37] op_sel_hi:[1,0,1]
    v_pk_fma_f32 v[38:39], v[134:135], v[58:59], v[38:39] op_sel_hi:[1,0,1]
    v_pk_fma_f32 v[40:41], v[136:137], v[58:59], v[40:41] op_sel_hi:[1,0,1]
    v_pk_fma_f32 v[42:43], v[138:139], v[58:59], v[42:43] op_sel_hi:[1,0,1]
    v_pk_fma_f32 v[44:45], v[140:141], v[58:59], v[44:45] op_sel_hi:[1,0,1]
    v_pk_fma_f32 v[46:47], v[142:143], v[58:59], v[46:47] op_sel_hi:[1,0,1]
    s_waitcnt lgkmcnt(0)
    v_pk_fma_f32 v[32:33], v[144:145], v[60:61], v[32:33] op_sel_hi:[1,0,1]
    v_pk_fma_f32 v[34:35], v[146:147], v[60:61], v[34:35] op_sel_hi:[1,0,1]
    v_pk_fma_f32 v[36:37], v[148:149], v[60:61], v[36:37] op_sel_hi:[1,0,1]
    v_pk_fma_f32 v[38:39], v[150:151], v[60:61], v[38:39] op_sel_hi:[1,0,1]
    v_pk_fma_f32 v[40:41], v[152:153], v[60:61], v[40:41] op_sel_hi:[1,0,1]
    v_pk_fma_f32 v[42:43], v[154:155], v[60:61], v[42:43] op_sel_hi:[1,0,1]
    v_pk_fma_f32 v[44:45], v[156:157], v[60:61], v[44:45] op_sel_hi:[1,0,1]
    v_pk_fma_f32 v[46:47], v[158:159], v[60:61], v[46:47] op_sel_hi:[1,0,1]
    v_cvt_pk_bf16_f32 v232, v32, v33
    v_cvt_pk_bf16_f32 v233, v34, v35
    v_cvt_pk_bf16_f32 v234, v36, v37
    v_cvt_pk_bf16_f32 v235, v38, v39
    v_cvt_pk_bf16_f32 v236, v40, v41
    v_cvt_pk_bf16_f32 v237, v42, v43
    v_cvt_pk_bf16_f32 v238, v44, v45
    v_cvt_pk_bf16_f32 v239, v46, v47
    s_nop 1
    v_permlane32_swap_b32 v232, v234
    v_permlane32_swap_b32 v233, v235
    v_permlane32_swap_b32 v236, v238
    v_permlane32_swap_b32 v237, v239
    buffer_store_dwordx4 v[232:235], v12, s[88:91], s97 offen
    buffer_store_dwordx4 v[236:239], v12, s[88:91], s97 offen offset:32
    s_endpgm
L_end:
    s_endpgm
L_stub_0:
    s_call_b64 s[24:25], L_rare_1
    s_branch L_ret_0
L_stub_1:
    s_call_b64 s[24:25], L_rare_0
    s_branch L_ret_1
L_stub_2:
    s_call_b64 s[24:25], L_rare_1
    s_branch L_ret_2
L_stub_3:
    s_call_b64 s[24:25], L_rare_0
    s_branch L_ret_3
L_stub_4:
    s_call_b64 s[24:25], L_rare_1
    s_branch L_ret_4
L_stub_5:
    s_call_b64 s[24:25], L_rare_0
    s_branch L_ret_5
L_stub_6:
    s_call_b64 s[24:25], L_rare_1
    s_branch L_ret_6
L_stub_7:
    s_call_b64 s[24:25], L_rare_0
    s_branch L_ret_7
L_stub_8:
    s_call_b64 s[24:25], L_rare_1
    s_branch L_ret_8
L_stub_9:
    s_call_b64 s[24:25], L_rare_0
    s_branch L_ret_9
L_stub_10:
    s_call_b64 s[24:25], L_rare_1
    s_branch L_ret_10
L_stub_11:
    s_call_b64 s[24:25], L_rare_0
    s_branch L_ret_11
L_stub_12:
    s_call_b64 s[24:25], L_rare_1
    s_branch L_ret_12
L_stub_13:
    s_call_b64 s[24:25], L_rare_0
    s_branch L_ret_13
L_stub_14:
    s_call_b64 s[24:25], L_rare_1
    s_branch L_ret_14
L_stub_15:
    s_call_b64 s[24:25], L_rare_0
    s_branch L_ret_15
L_stub_16:
    s_call_b64 s[24:25], L_rare_1
    s_branch L_ret_16
L_stub_17:
    s_call_b64 s[24:25], L_rare_0
    s_branch L_ret_17
L_stub_18:
    s_call_b64 s[24:25], L_rare_1
    s_branch L_ret_18
L_stub_19:
    s_call_b64 s[24:25], L_rare_0
    s_branch L_ret_19
L_stub_20:
    s_call_b64 s[24:25], L_rare_1
    s_branch L_ret_20
L_stub_21:
    s_call_b64 s[24:25], L_rare_0
    s_branch L_ret_21
L_stub_22:
    s_call_b64 s[24:25], L_rare_1
    s_branch L_ret_22
L_stub_23:
    s_call_b64 s[24:25], L_rare_0
    s_branch L_ret_23
L_stub_24:
    s_call_b64 s[24:25], L_rare_1
    s_branch L_ret_24
L_stub_25:
    s_call_b64 s[24:25], L_rare_0
    s_branch L_ret_25
L_stub_26:
    s_call_b64 s[24:25], L_rare_1
    s_branch L_ret_26
L_stub_27:
    s_call_b64 s[24:25], L_rare_0
    s_branch L_ret_27
L_stub_28:
    s_call_b64 s[24:25], L_rare_1
    s_branch L_ret_28
L_stub_29:
    s_call_b64 s[24:25], L_rare_0
    s_branch L_ret_29
L_stub_30:
    s_call_b64 s[24:25], L_rare_1
    s_branch L_ret_30
L_stub_31:
    s_call_b64 s[24:25], L_rare_1
    s_branch L_ret_31
L_stub_32:
    s_call_b64 s[24:25], L_rare_1
    s_branch L_ret_32
L_stub_33:
    s_call_b64 s[24:25], L_rare_1
    s_branch L_ret_33
L_spin_0:
    s_mov_b32 s101, 0
L_spinl_0:
    s_sleep 4
    buffer_load_dwordx2 v[54:55], v51, s[92:95], 0 offen offset:0 sc1
    s_add_u32 s101, s101, 1
    s_cmp_gt_u32 s101, 0x40000
    s_cbranch_scc1 L_spinout_0
    s_waitcnt vmcnt(0)
    v_cmp_ne_u64 vcc, s[96:97], v[54:55]
    s_cbranch_vccnz L_spinl_0
L_spinout_0:
    s_waitcnt vmcnt(0)
    s_branch L_spinret_0
L_spin_1:
    s_mov_b32 s101, 0
L_spinl_1:
    s_sleep 4
    buffer_load_dwordx2 v[54:55], v51, s[92:95], 0 offen offset:1024 sc1
    s_add_u32 s101, s101, 1
    s_cmp_gt_u32 s101, 0x40000
    s_cbranch_scc1 L_spinout_1
    s_waitcnt vmcnt(0)
    v_cmp_ne_u64 vcc, s[96:97], v[54:55]
    s_cbranch_vccnz L_spinl_1
L_spinout_1:
    s_waitcnt vmcnt(0)
    s_branch L_spinret_1
L_spin_2:
    s_mov_b32 s101, 0
L_spinl_2:
    s_sleep 4
    buffer_load_dwordx2 v[54:55], v51, s[92:95], 0 offen offset:2048 sc1
    s_add_u32 s101, s101, 1
    s_cmp_gt_u32 s101, 0x40000
    s_cbranch_scc1 L_spinout_2
    s_waitcnt vmcnt(0)
    v_cmp_ne_u64 vcc, s[96:97], v[54:55]
    s_cbranch_vccnz L_spinl_2
L_spinout_2:
    s_waitcnt vmcnt(0)
    s_branch L_spinret_2
L_spin_3:
    s_mov_b32 s101, 0
L_spinl_3:
    s_sleep 4
    buffer_load_dwordx2 v[54:55], v51, s[92:95], 0 offen offset:3072 sc1
    s_add_u32 s101, s101, 1
    s_cmp_gt_u32 s101, 0x40000
    s_cbranch_scc1 L_spinout_3
    s_waitcnt vmcnt(0)
    v_cmp_ne_u64 vcc, s[96:97], v[54:55]
    s_cbranch_vccnz L_spinl_3
L_spinout_3:
    s_waitcnt vmcnt(0)
    s_branch L_spinret_3
L_epoch1:
    s_mov_b32 s101, 0x100c00
    buffer_load_dwordx4 v[8:11], v4, s[92:95], s101 offen sc1
    s_mov_b32 s101, 0x300c00
    buffer_load_dwordx4 v[12:15], v4, s[92:95], s101 offen sc1
    s_mov_b32 s101, 0x500c00
    buffer_load_dwordx4 v[16:19], v4, s[92:95], s101 offen sc1
    s_mov_b32 s101, 0x700c00
    buffer_load_dwordx4 v[20:23], v4, s[92:95], s101 offen sc1
    s_mov_b32 s101, 0x900c00
    buffer_load_dwordx4 v[24:27], v4, s[92:95], s101 offen sc1
    s_mov_b32 s101, 0xb00c00
    buffer_load_dwordx4 v[28:31], v4, s[92:95], s101 offen sc1
    s_mov_b32 s101, 0xd00c00
    buffer_load_dwordx4 v[32:35], v4, s[92:95], s101 offen sc1
    s_mov_b32 s101, 0xf00c00
    buffer_load_dwordx4 v[36:39], v4, s[92:95], s101 offen sc1
    s_branch L_epochret1
L_epoch2:
    s_mov_b32 s30, 0
L_epochl:
    s_mov_b64 s[28:29], 0
    v_cmp_ne_u64 vcc, s[96:97], v[8:9]
    s_or_b64 s[28:29], s[28:29], vcc
    v_cmp_ne_u64 vcc, s[96:97], v[10:11]
    s_or_b64 s[28:29], s[28:29], vcc
    v_cmp_ne_u64 vcc, s[96:97], v[12:13]
    s_or_b64 s[28:29], s[28:29], vcc
    v_cmp_ne_u64 vcc, s[96:97], v[14:15]
    s_or_b64 s[28:29], s[28:29], vcc
    v_cmp_ne_u64 vcc, s[96:97], v[16:17]
    s_or_b64 s[28:29], s[28:29], vcc
    v_cmp_ne_u64 vcc, s[96:97], v[18:19]
    s_or_b64 s[28:29], s[28:29], vcc
    v_cmp_ne_u64 vcc, s[96:97], v[20:21]
    s_or_b64 s[28:29], s[28:29], vcc
    v_cmp_ne_u64 vcc, s[96:97], v[22:23]
    s_or_b64 s[28:29], s[28:29], vcc
    v_cmp_ne_u64 vcc, s[96:97], v[24:25]
    s_or_b64 s[28:29], s[28:29], vcc
    v_cmp_ne_u64 vcc, s[96:97], v[26:27]
    s_or_b64 s[28:29], s[28:29], vcc
    v_cmp_ne_u64 vcc, s[96:97], v[28:29]
    s_or_b64 s[28:29], s[28:29], vcc
    v_cmp_ne_u64 vcc, s[96:97], v[30:31]
    s_or_b64 s[28:29], s[28:29], vcc
    v_cmp_ne_u64 vcc, s[96:97], v[32:33]
    s_or_b64 s[28:29], s[28:29], vcc
    v_cmp_ne_u64 vcc, s[96:97], v[34:35]
    s_or_b64 s[28:29], s[28:29], vcc
    v_cmp_ne_u64 vcc, s[96:97], v[36:37]
    s_or_b64 s[28:29], s[28:29], vcc
    v_cmp_ne_u64 vcc, s[96:97], v[38:39]
    s_or_b64 s[28:29], s[28:29], vcc
    s_cmp_eq_u64 s[28:29], 0
    s_cbranch_scc1 L_epocho
    s_sleep 8
    s_mov_b32 s101, 0x100c00
    buffer_load_dwordx4 v[8:11], v4, s[92:95], s101 offen sc1
    s_mov_b32 s101, 0x300c00
    buffer_load_dwordx4 v[12:15], v4, s[92:95], s101 offen sc1
    s_mov_b32 s101, 0x500c00
    buffer_load_dwordx4 v[16:19], v4, s[92:95], s101 offen sc1
    s_mov_b32 s101, 0x700c00
    buffer_load_dwordx4 v[20:23], v4, s[92:95], s101 offen sc1
    s_mov_b32 s101, 0x900c00
    buffer_load_dwordx4 v[24:27], v4, s[92:95], s101 offen sc1
    s_mov_b32 s101, 0xb00c00
    buffer_load_dwordx4 v[28:31], v4, s[92:95], s101 offen sc1
    s_mov_b32 s101, 0xd00c00
    buffer_load_dwordx4 v[32:35], v4, s[92:95], s101 offen sc1
    s_mov_b32 s101, 0xf00c00
    buffer_load_dwordx4 v[36:39], v4, s[92:95], s101 offen sc1
    s_waitcnt vmcnt(0)
    s_add_u32 s30, s30, 1
    s_cmp_lt_u32 s30, 0x40000
    s_cbranch_scc1 L_epochl
L_epocho:
    v_mov_b32 v60, 0x1000000
    s_mov_b64 exec, 1
    buffer_store_dwordx2 v[52:53], v60, s[92:95], 0 offen sc1
    s_mov_b64 exec, -1
    s_branch L_epochret2
L_code_end:
L_rare_0:
    s_nop 7
    s_nop 7
    v_max3_f32 v246, v128, v129, v130
    v_max3_f32 v246, v246, v131, v132
    v_max3_f32 v246, v246, v133, v134
    v_max3_f32 v246, v246, v135, v136
    v_max3_f32 v246, v246, v137, v138
    v_max3_f32 v246, v246, v139, v140
    v_max3_f32 v246, v246, v141, v142
    v_max_f32 v246, v246, v143
    v_mov_b32 v247, v246
    s_nop 1
    v_permlane32_swap_b32 v246, v247
    s_nop 1
    v_max3_f32 v246, v246, v247, 0
    v_exp_f32 v247, -v246
    v_add_f32 v244, v244, v246
    v_sub_f32 v248, 0, v244
    v_mov_b32 v160, v248
    v_mov_b32 v161, v248
    v_mov_b32 v162, v248
    v_mov_b32 v163, v248
    v_mov_b32 v164, v248
    v_mov_b32 v165, v248
    v_mov_b32 v166, v248
    v_mov_b32 v167, v248
    v_mov_b32 v168, v248
    v_mov_b32 v169, v248
    v_mov_b32 v170, v248
    v_mov_b32 v171, v248
    v_mov_b32 v172, v248
    v_mov_b32 v173, v248
    v_mov_b32 v174, v248
    v_mov_b32 v175, v248
    v_mul_f32 v242, v242, v247
    v_accvgpr_read_b32 v249, a0
    v_mul_f32 v249, v249, v247
    v_accvgpr_write_b32 a0, v249
    v_accvgpr_read_b32 v250, a1
    v_mul_f32 v250, v250, v247
    v_accvgpr_write_b32 a1, v250
    v_accvgpr_read_b32 v251, a2
    v_mul_f32 v251, v251, v247
    v_accvgpr_write_b32 a2, v251
    v_accvgpr_read_b32 v252, a3
    v_mul_f32 v252, v252, v247
    v_accvgpr_write_b32 a3, v252
    v_accvgpr_read_b32 v249, a4
    v_mul_f32 v249, v249, v247
    v_accvgpr_write_b32 a4, v249
    v_accvgpr_read_b32 v250, a5
    v_mul_f32 v250, v250, v247
    v_accvgpr_write_b32 a5, v250
    v_accvgpr_read_b32 v251, a6
    v_mul_f32 v251, v251, v247
    v_accvgpr_write_b32 a6, v251
    v_accvgpr_read_b32 v252, a7
    v_mul_f32 v252, v252, v247
    v_accvgpr_write_b32 a7, v252
    v_accvgpr_read_b32 v249, a8
    v_mul_f32 v249, v249, v247
    v_accvgpr_write_b32 a8, v249
    v_accvgpr_read_b32 v250, a9
    v_mul_f32 v250, v250, v247
    v_accvgpr_write_b32 a9, v250
    v_accvgpr_read_b32 v251, a10
    v_mul_f32 v251, v251, v247
    v_accvgpr_write_b32 a10, v251
    v_accvgpr_read_b32 v252, a11
    v_mul_f32 v252, v252, v247
    v_accvgpr_write_b32 a11, v252
    v_accvgpr_read_b32 v249, a12
    v_mul_f32 v249, v249, v247
    v_accvgpr_write_b32 a12, v249
    v_accvgpr_read_b32 v250, a13
    v_mul_f32 v250, v250, v247
    v_accvgpr_write_b32 a13, v250
    v_accvgpr_read_b32 v251, a14
    v_mul_f32 v251, v251, v247
    v_accvgpr_write_b32 a14, v251
    v_accvgpr_read_b32 v252, a15
    v_mul_f32 v252, v252, v247
    v_accvgpr_write_b32 a15, v252
    v_accvgpr_read_b32 v249, a16
    v_mul_f32 v249, v249, v247
    v_accvgpr_write_b32 a16, v249
    v_accvgpr_read_b32 v250, a17
    v_mul_f32 v250, v250, v247
    v_accvgpr_write_b32 a17, v250
    v_accvgpr_read_b32 v251, a18
    v_mul_f32 v251, v251, v247
    v_accvgpr_write_b32 a18, v251
    v_accvgpr_read_b32 v252, a19
    v_mul_f32 v252, v252, v247
    v_accvgpr_write_b32 a19, v252
    v_accvgpr_read_b32 v249, a20
    v_mul_f32 v249, v249, v247
    v_accvgpr_write_b32 a20, v249
    v_accvgpr_read_b32 v250, a21
    v_mul_f32 v250, v250, v247
    v_accvgpr_write_b32 a21, v250
    v_accvgpr_read_b32 v251, a22
    v_mul_f32 v251, v251, v247
    v_accvgpr_write_b32 a22, v251
    v_accvgpr_read_b32 v252, a23
    v_mul_f32 v252, v252, v247
    v_accvgpr_write_b32 a23, v252
    v_accvgpr_read_b32 v249, a24
    v_mul_f32 v249, v249, v247
    v_accvgpr_write_b32 a24, v249
    v_accvgpr_read_b32 v250, a25
    v_mul_f32 v250, v250, v247
    v_accvgpr_write_b32 a25, v250
    v_accvgpr_read_b32 v251, a26
    v_mul_f32 v251, v251, v247
    v_accvgpr_write_b32 a26, v251
    v_accvgpr_read_b32 v252, a27
    v_mul_f32 v252, v252, v247
    v_accvgpr_write_b32 a27, v252
    v_accvgpr_read_b32 v249, a28
    v_mul_f32 v249, v249, v247
    v_accvgpr_write_b32 a28, v249
    v_accvgpr_read_b32 v250, a29
    v_mul_f32 v250, v250, v247
    v_accvgpr_write_b32 a29, v250
    v_accvgpr_read_b32 v251, a30
    v_mul_f32 v251, v251, v247
    v_accvgpr_write_b32 a30, v251
    v_accvgpr_read_b32 v252, a31
    v_mul_f32 v252, v252, v247
    v_accvgpr_write_b32 a31, v252
    v_accvgpr_read_b32 v249, a32
    v_mul_f32 v249, v249, v247
    v_accvgpr_write_b32 a32, v249
    v_accvgpr_read_b32 v250, a33
    v_mul_f32 v250, v250, v247
    v_accvgpr_write_b32 a33, v250
    v_accvgpr_read_b32 v251, a34
    v_mul_f32 v251, v251, v247
    v_accvgpr_write_b32 a34, v251
    v_accvgpr_read_b32 v252, a35
    v_mul_f32 v252, v252, v247
    v_accvgpr_write_b32 a35, v252
    v_accvgpr_read_b32 v249, a36
    v_mul_f32 v249, v249, v247
    v_accvgpr_write_b32 a36, v249
    v_accvgpr_read_b32 v250, a37
    v_mul_f32 v250, v250, v247
    v_accvgpr_write_b32 a37, v250
    v_accvgpr_read_b32 v251, a38
    v_mul_f32 v251, v251, v247
    v_accvgpr_write_b32 a38, v251
    v_accvgpr_read_b32 v252, a39
    v_mul_f32 v252, v252, v247
    v_accvgpr_write_b32 a39, v252
    v_accvgpr_read_b32 v249, a40
    v_mul_f32 v249, v249, v247
    v_accvgpr_write_b32 a40, v249
    v_accvgpr_read_b32 v250, a41
    v_mul_f32 v250, v250, v247
    v_accvgpr_write_b32 a41, v250
    v_accvgpr_read_b32 v251, a42
    v_mul_f32 v251, v251, v247
    v_accvgpr_write_b32 a42, v251
    v_accvgpr_read_b32 v252, a43
    v_mul_f32 v252, v252, v247
    v_accvgpr_write_b32 a43, v252
    v_accvgpr_read_b32 v249, a44
    v_mul_f32 v249, v249, v247
    v_accvgpr_write_b32 a44, v249
    v_accvgpr_read_b32 v250, a45
    v_mul_f32 v250, v250, v247
    v_accvgpr_write_b32 a45, v250
    v_accvgpr_read_b32 v251, a46
    v_mul_f32 v251, v251, v247
    v_accvgpr_write_b32 a46, v251
    v_accvgpr_read_b32 v252, a47
    v_mul_f32 v252, v252, v247
    v_accvgpr_write_b32 a47, v252
    v_accvgpr_read_b32 v249, a48
    v_mul_f32 v249, v249, v247
    v_accvgpr_write_b32 a48, v249
    v_accvgpr_read_b32 v250, a49
    v_mul_f32 v250, v250, v247
    v_accvgpr_write_b32 a49, v250
    v_accvgpr_read_b32 v251, a50
    v_mul_f32 v251, v251, v247
    v_accvgpr_write_b32 a50, v251
    v_accvgpr_read_b32 v252, a51
    v_mul_f32 v252, v252, v247
    v_accvgpr_write_b32 a51, v252
    v_accvgpr_read_b32 v249, a52
    v_mul_f32 v249, v249, v247
    v_accvgpr_write_b32 a52, v249
    v_accvgpr_read_b32 v250, a53
    v_mul_f32 v250, v250, v247
    v_accvgpr_write_b32 a53, v250
    v_accvgpr_read_b32 v251, a54
    v_mul_f32 v251, v251, v247
    v_accvgpr_write_b32 a54, v251
    v_accvgpr_read_b32 v252, a55
    v_mul_f32 v252, v252, v247
    v_accvgpr_write_b32 a55, v252
    v_accvgpr_read_b32 v249, a56
    v_mul_f32 v249, v249, v247
    v_accvgpr_write_b32 a56, v249
    v_accvgpr_read_b32 v250, a57
    v_mul_f32 v250, v250, v247
    v_accvgpr_write_b32 a57, v250
    v_accvgpr_read_b32 v251, a58
    v_mul_f32 v251, v251, v247
    v_accvgpr_write_b32 a58, v251
    v_accvgpr_read_b32 v252, a59
    v_mul_f32 v252, v252, v247
    v_accvgpr_write_b32 a59, v252
    v_accvgpr_read_b32 v249, a60
    v_mul_f32 v249, v249, v247
    v_accvgpr_write_b32 a60, v249
    v_accvgpr_read_b32 v250, a61
    v_mul_f32 v250, v250, v247
    v_accvgpr_write_b32 a61, v250
    v_accvgpr_read_b32 v251, a62
    v_mul_f32 v251, v251, v247
    v_accvgpr_write_b32 a62, v251
    v_accvgpr_read_b32 v252, a63
    v_mul_f32 v252, v252, v247
    v_accvgpr_write_b32 a63, v252
    v_sub_f32 v128, v128, v246
    v_sub_f32 v129, v129, v246
    v_sub_f32 v130, v130, v246
    v_sub_f32 v131, v131, v246
    v_sub_f32 v132, v132, v246
    v_sub_f32 v133, v133, v246
    v_sub_f32 v134, v134, v246
    v_sub_f32 v135, v135, v246
    v_sub_f32 v136, v136, v246
    v_sub_f32 v137, v137, v246
    v_sub_f32 v138, v138, v246
    v_sub_f32 v139, v139, v246
    v_sub_f32 v140, v140, v246
    v_sub_f32 v141, v141, v246
    v_sub_f32 v142, v142, v246
    v_sub_f32 v143, v143, v246
    v_exp_f32 v192, v128
    v_exp_f32 v193, v129
    v_exp_f32 v194, v130
    v_exp_f32 v195, v131
    v_exp_f32 v196, v132
    v_exp_f32 v197, v133
    v_exp_f32 v198, v134
    v_exp_f32 v199, v135
    v_exp_f32 v200, v136
    v_exp_f32 v201, v137
    v_exp_f32 v202, v138
    v_exp_f32 v203, v139
    v_exp_f32 v204, v140
    v_exp_f32 v205, v141
    v_exp_f32 v206, v142
    v_exp_f32 v207, v143
    s_nop 0
    v_add_f32 v240, v192, v193
    v_add_f32 v240, v240, v194
    v_add_f32 v240, v240, v195
    v_add_f32 v240, v240, v196
    v_add_f32 v240, v240, v197
    v_add_f32 v240, v240, v198
    v_add_f32 v240, v240, v199
    v_add_f32 v240, v240, v200
    v_add_f32 v240, v240, v201
    v_add_f32 v240, v240, v202
    v_add_f32 v240, v240, v203
    v_add_f32 v240, v240, v204
    v_add_f32 v240, v240, v205
    v_add_f32 v240, v240, v206
    v_add_f32 v240, v240, v207
    v_cvt_pk_bf16_f32 v224, v192, v193
    v_cvt_pk_bf16_f32 v225, v194, v195
    v_cvt_pk_bf16_f32 v226, v196, v197
    v_cvt_pk_bf16_f32 v227, v198, v199
    v_cvt_pk_bf16_f32 v228, v200, v201
    v_cvt_pk_bf16_f32 v229, v202, v203
    v_cvt_pk_bf16_f32 v230, v204, v205
    v_cvt_pk_bf16_f32 v231, v206, v207
    s_nop 3
    s_setpc_b64 s[24:25]
L_rare_1:
    s_nop 7
    s_nop 7
    v_max3_f32 v246, v144, v145, v146
    v_max3_f32 v246, v246, v147, v148
    v_max3_f32 v246, v246, v149, v150
    v_max3_f32 v246, v246, v151, v152
    v_max3_f32 v246, v246, v153, v154
    v_max3_f32 v246, v246, v155, v156
    v_max3_f32 v246, v246, v157, v158
    v_max_f32 v246, v246, v159
    v_mov_b32 v247, v246
    s_nop 1
    v_permlane32_swap_b32 v246, v247
    s_nop 1
    v_max3_f32 v246, v246, v247, 0
    v_exp_f32 v247, -v246
    v_add_f32 v245, v245, v246
    v_sub_f32 v248, 0, v245
    v_mov_b32 v176, v248
    v_mov_b32 v177, v248
    v_mov_b32 v178, v248
    v_mov_b32 v179, v248
    v_mov_b32 v180, v248
    v_mov_b32 v181, v248
    v_mov_b32 v182, v248
    v_mov_b32 v183, v248
    v_mov_b32 v184, v248
    v_mov_b32 v185, v248
    v_mov_b32 v186, v248
    v_mov_b32 v187, v248
    v_mov_b32 v188, v248
    v_mov_b32 v189, v248
    v_mov_b32 v190, v248
    v_mov_b32 v191, v248
    v_mul_f32 v243, v243, v247
    v_accvgpr_read_b32 v249, a64
    v_mul_f32 v249, v249, v247
    v_accvgpr_write_b32 a64, v249
    v_accvgpr_read_b32 v250, a65
    v_mul_f32 v250, v250, v247
    v_accvgpr_write_b32 a65, v250
    v_accvgpr_read_b32 v251, a66
    v_mul_f32 v251, v251, v247
    v_accvgpr_write_b32 a66, v251
    v_accvgpr_read_b32 v252, a67
    v_mul_f32 v252, v252, v247
    v_accvgpr_write_b32 a67, v252
    v_accvgpr_read_b32 v249, a68
    v_mul_f32 v249, v249, v247
    v_accvgpr_write_b32 a68, v249
    v_accvgpr_read_b32 v250, a69
    v_mul_f32 v250, v250, v247
    v_accvgpr_write_b32 a69, v250
    v_accvgpr_read_b32 v251, a70
    v_mul_f32 v251, v251, v247
    v_accvgpr_write_b32 a70, v251
    v_accvgpr_read_b32 v252, a71
    v_mul_f32 v252, v252, v247
    v_accvgpr_write_b32 a71, v252
    v_accvgpr_read_b32 v249, a72
    v_mul_f32 v249, v249, v247
    v_accvgpr_write_b32 a72, v249
    v_accvgpr_read_b32 v250, a73
    v_mul_f32 v250, v250, v247
    v_accvgpr_write_b32 a73, v250
    v_accvgpr_read_b32 v251, a74
    v_mul_f32 v251, v251, v247
    v_accvgpr_write_b32 a74, v251
    v_accvgpr_read_b32 v252, a75
    v_mul_f32 v252, v252, v247
    v_accvgpr_write_b32 a75, v252
    v_accvgpr_read_b32 v249, a76
    v_mul_f32 v249, v249, v247
    v_accvgpr_write_b32 a76, v249
    v_accvgpr_read_b32 v250, a77
    v_mul_f32 v250, v250, v247
    v_accvgpr_write_b32 a77, v250
    v_accvgpr_read_b32 v251, a78
    v_mul_f32 v251, v251, v247
    v_accvgpr_write_b32 a78, v251
    v_accvgpr_read_b32 v252, a79
    v_mul_f32 v252, v252, v247
    v_accvgpr_write_b32 a79, v252
    v_accvgpr_read_b32 v249, a80
    v_mul_f32 v249, v249, v247
    v_accvgpr_write_b32 a80, v249
    v_accvgpr_read_b32 v250, a81
    v_mul_f32 v250, v250, v247
    v_accvgpr_write_b32 a81, v250
    v_accvgpr_read_b32 v251, a82
    v_mul_f32 v251, v251, v247
    v_accvgpr_write_b32 a82, v251
    v_accvgpr_read_b32 v252, a83
    v_mul_f32 v252, v252, v247
    v_accvgpr_write_b32 a83, v252
    v_accvgpr_read_b32 v249, a84
    v_mul_f32 v249, v249, v247
    v_accvgpr_write_b32 a84, v249
    v_accvgpr_read_b32 v250, a85
    v_mul_f32 v250, v250, v247
    v_accvgpr_write_b32 a85, v250
    v_accvgpr_read_b32 v251, a86
    v_mul_f32 v251, v251, v247
    v_accvgpr_write_b32 a86, v251
    v_accvgpr_read_b32 v252, a87
    v_mul_f32 v252, v252, v247
    v_accvgpr_write_b32 a87, v252
    v_accvgpr_read_b32 v249, a88
    v_mul_f32 v249, v249, v247
    v_accvgpr_write_b32 a88, v249
    v_accvgpr_read_b32 v250, a89
    v_mul_f32 v250, v250, v247
    v_accvgpr_write_b32 a89, v250
    v_accvgpr_read_b32 v251, a90
    v_mul_f32 v251, v251, v247
    v_accvgpr_write_b32 a90, v251
    v_accvgpr_read_b32 v252, a91
    v_mul_f32 v252, v252, v247
    v_accvgpr_write_b32 a91, v252
    v_accvgpr_read_b32 v249, a92
    v_mul_f32 v249, v249, v247
    v_accvgpr_write_b32 a92, v249
    v_accvgpr_read_b32 v250, a93
    v_mul_f32 v250, v250, v247
    v_accvgpr_write_b32 a93, v250
    v_accvgpr_read_b32 v251, a94
    v_mul_f32 v251, v251, v247
    v_accvgpr_write_b32 a94, v251
    v_accvgpr_read_b32 v252, a95
    v_mul_f32 v252, v252, v247
    v_accvgpr_write_b32 a95, v252
    v_accvgpr_read_b32 v249, a96
    v_mul_f32 v249, v249, v247
    v_accvgpr_write_b32 a96, v249
    v_accvgpr_read_b32 v250, a97
    v_mul_f32 v250, v250, v247
    v_accvgpr_write_b32 a97, v250
    v_accvgpr_read_b32 v251, a98
    v_mul_f32 v251, v251, v247
    v_accvgpr_write_b32 a98, v251
    v_accvgpr_read_b32 v252, a99
    v_mul_f32 v252, v252, v247
    v_accvgpr_write_b32 a99, v252
    v_accvgpr_read_b32 v249, a100
    v_mul_f32 v249, v249, v247
    v_accvgpr_write_b32 a100, v249
    v_accvgpr_read_b32 v250, a101
    v_mul_f32 v250, v250, v247
    v_accvgpr_write_b32 a101, v250
    v_accvgpr_read_b32 v251, a102
    v_mul_f32 v251, v251, v247
    v_accvgpr_write_b32 a102, v251
    v_accvgpr_read_b32 v252, a103
    v_mul_f32 v252, v252, v247
    v_accvgpr_write_b32 a103, v252
    v_accvgpr_read_b32 v249, a104
    v_mul_f32 v249, v249, v247
    v_accvgpr_write_b32 a104, v249
    v_accvgpr_read_b32 v250, a105
    v_mul_f32 v250, v250, v247
    v_accvgpr_write_b32 a105, v250
    v_accvgpr_read_b32 v251, a106
    v_mul_f32 v251, v251, v247
    v_accvgpr_write_b32 a106, v251
    v_accvgpr_read_b32 v252, a107
    v_mul_f32 v252, v252, v247
    v_accvgpr_write_b32 a107, v252
    v_accvgpr_read_b32 v249, a108
    v_mul_f32 v249, v249, v247
    v_accvgpr_write_b32 a108, v249
    v_accvgpr_read_b32 v250, a109
    v_mul_f32 v250, v250, v247
    v_accvgpr_write_b32 a109, v250
    v_accvgpr_read_b32 v251, a110
    v_mul_f32 v251, v251, v247
    v_accvgpr_write_b32 a110, v251
    v_accvgpr_read_b32 v252, a111
    v_mul_f32 v252, v252, v247
    v_accvgpr_write_b32 a111, v252
    v_accvgpr_read_b32 v249, a112
    v_mul_f32 v249, v249, v247
    v_accvgpr_write_b32 a112, v249
    v_accvgpr_read_b32 v250, a113
    v_mul_f32 v250, v250, v247
    v_accvgpr_write_b32 a113, v250
    v_accvgpr_read_b32 v251, a114
    v_mul_f32 v251, v251, v247
    v_accvgpr_write_b32 a114, v251
    v_accvgpr_read_b32 v252, a115
    v_mul_f32 v252, v252, v247
    v_accvgpr_write_b32 a115, v252
    v_accvgpr_read_b32 v249, a116
    v_mul_f32 v249, v249, v247
    v_accvgpr_write_b32 a116, v249
    v_accvgpr_read_b32 v250, a117
    v_mul_f32 v250, v250, v247
    v_accvgpr_write_b32 a117, v250
    v_accvgpr_read_b32 v251, a118
    v_mul_f32 v251, v251, v247
    v_accvgpr_write_b32 a118, v251
    v_accvgpr_read_b32 v252, a119
    v_mul_f32 v252, v252, v247
    v_accvgpr_write_b32 a119, v252
    v_accvgpr_read_b32 v249, a120
    v_mul_f32 v249, v249, v247
    v_accvgpr_write_b32 a120, v249
    v_accvgpr_read_b32 v250, a121
    v_mul_f32 v250, v250, v247
    v_accvgpr_write_b32 a121, v250
    v_accvgpr_read_b32 v251, a122
    v_mul_f32 v251, v251, v247
    v_accvgpr_write_b32 a122, v251
    v_accvgpr_read_b32 v252, a123
    v_mul_f32 v252, v252, v247
    v_accvgpr_write_b32 a123, v252
    v_accvgpr_read_b32 v249, a124
    v_mul_f32 v249, v249, v247
    v_accvgpr_write_b32 a124, v249
    v_accvgpr_read_b32 v250, a125
    v_mul_f32 v250, v250, v247
    v_accvgpr_write_b32 a125, v250
    v_accvgpr_read_b32 v251, a126
    v_mul_f32 v251, v251, v247
    v_accvgpr_write_b32 a126, v251
    v_accvgpr_read_b32 v252, a127
    v_mul_f32 v252, v252, v247
    v_accvgpr_write_b32 a127, v252
    v_sub_f32 v144, v144, v246
    v_sub_f32 v145, v145, v246
    v_sub_f32 v146, v146, v246
    v_sub_f32 v147, v147, v246
    v_sub_f32 v148, v148, v246
    v_sub_f32 v149, v149, v246
    v_sub_f32 v150, v150, v246
    v_sub_f32 v151, v151, v246
    v_sub_f32 v152, v152, v246
    v_sub_f32 v153, v153, v246
    v_sub_f32 v154, v154, v246
    v_sub_f32 v155, v155, v246
    v_sub_f32 v156, v156, v246
    v_sub_f32 v157, v157, v246
    v_sub_f32 v158, v158, v246
    v_sub_f32 v159, v159, v246
    v_exp_f32 v192, v144
    v_exp_f32 v193, v145
    v_exp_f32 v194, v146
    v_exp_f32 v195, v147
    v_exp_f32 v196, v148
    v_exp_f32 v197, v149
    v_exp_f32 v198, v150
    v_exp_f32 v199, v151
    v_exp_f32 v200, v152
    v_exp_f32 v201, v153
    v_exp_f32 v202, v154
    v_exp_f32 v203, v155
    v_exp_f32 v204, v156
    v_exp_f32 v205, v157
    v_exp_f32 v206, v158
    v_exp_f32 v207, v159
    s_nop 0
    v_add_f32 v241, v192, v193
    v_add_f32 v241, v241, v194
    v_add_f32 v241, v241, v195
    v_add_f32 v241, v241, v196
    v_add_f32 v241, v241, v197
    v_add_f32 v241, v241, v198
    v_add_f32 v241, v241, v199
    v_add_f32 v241, v241, v200
    v_add_f32 v241, v241, v201
    v_add_f32 v241, v241, v202
    v_add_f32 v241, v241, v203
    v_add_f32 v241, v241, v204
    v_add_f32 v241, v241, v205
    v_add_f32 v241, v241, v206
    v_add_f32 v241, v241, v207
    v_cvt_pk_bf16_f32 v232, v192, v193
    v_cvt_pk_bf16_f32 v233, v194, v195
    v_cvt_pk_bf16_f32 v234, v196, v197
    v_cvt_pk_bf16_f32 v235, v198, v199
    v_cvt_pk_bf16_f32 v236, v200, v201
    v_cvt_pk_bf16_f32 v237, v202, v203
    v_cvt_pk_bf16_f32 v238, v204, v205
    v_cvt_pk_bf16_f32 v239, v206, v207
    s_nop 3
    s_setpc_b64 s[24:25]
.section .rodata,"a"
.p2align 6
.amdhsa_kernel standalone__kv_cache_quant_pre_rope_vs_post_rope__prompt_kernel
  .amdhsa_next_free_vgpr 512
  .amdhsa_next_free_sgpr 102
  .amdhsa_accum_offset 256
  .amdhsa_group_segment_fixed_size 0
  .amdhsa_kernarg_size 112
  .amdhsa_user_sgpr_count 2
  .amdhsa_user_sgpr_kernarg_segment_ptr 1
  .amdhsa_system_sgpr_workgroup_id_x 1
  .amdhsa_float_denorm_mode_32 3
.end_amdhsa_kernel
```
